```python
import torch

def _softmax(x, axis=-1):
    return torch.softmax(x, dim=axis)
def _gelu(x):
    return torch.nn.functional.gelu(x, approximate="tanh")
def _silu(x):
    return torch.nn.functional.silu(x)
def _sigmoid(x):
    return torch.sigmoid(x)
def _layernorm(x, axis=-1, eps=1e-5):
    m = x.mean(dim=axis, keepdim=True)
    v = x.var(dim=axis, keepdim=True, unbiased=False)
    return (x - m) / torch.sqrt(v + eps)
def _scatter_add(tgt, idx, src, axis=0):
    return tgt.clone().index_add_(axis, idx, src)
def _segment_sum(src, seg, n):
    out = torch.zeros((n,) + src.shape[1:], dtype=src.dtype)
    return out.index_add_(0, seg, src)
def _pad(x, pw):
    flat = tuple(v for pair in reversed(pw) for v in pair)
    return torch.nn.functional.pad(x, flat)

kernel_name = 'sequential_preLN__compressed_kv_cla__swiglu_ffn__decode'

def setup_inputs():

    _w = (lambda a: (lambda t: t.to(torch.bfloat16) if t.is_floating_point() else t)(torch.as_tensor(a)))
    def _A_setup():
        B, H, Sq, Sk, D, M = 4, 32, 1, 4096, 128, 512
        Dc = 4 * D
        return {
            "x": _w((lambda *s: torch.randn(*s, dtype=torch.bfloat16) * 0.05)(B, Sq, M)),
            "c_kv": _w((lambda *s: torch.randn(*s, dtype=torch.bfloat16) * 0.4)(B, Sk, Dc)),
            "w_q": _w((lambda *s: torch.randn(*s, dtype=torch.bfloat16) * 3.2)(M, H, D) * (M ** -0.5)),
            "w_uk": _w((lambda *s: torch.randn(*s, dtype=torch.bfloat16) * 3.2)(Dc, H, D) * (Dc ** -0.5)),
            "w_uv": _w((lambda *s: torch.randn(*s, dtype=torch.bfloat16) * 0.4)(Dc, H, D) * (Dc ** -0.5)),
            "w_o": _w((lambda *s: torch.randn(*s, dtype=torch.bfloat16) * 0.4)(H, D, M) * ((H * D) ** -0.5)),
        }
    _A_in = _A_setup()

    def _B_setup():
        B, S, D, F = 4, 1, 512, 1376
        return {
            "x": _w((lambda *s: torch.randn(*s, dtype=torch.bfloat16) * 0.05)(B, S, D)),
            "w_gate": _w((lambda *s: torch.randn(*s, dtype=torch.bfloat16) * 0.05)(D, F)),
            "w_up": _w((lambda *s: torch.randn(*s, dtype=torch.bfloat16) * 0.05)(D, F)),
            "w_down": _w((lambda *s: torch.randn(*s, dtype=torch.bfloat16) * 0.05)(F, D)),
        }
    _B_in = _B_setup()

    return {
        "A_x": _A_in["x"],
        "A_c_kv": _A_in["c_kv"],
        "A_w_q": _A_in["w_q"],
        "A_w_uk": _A_in["w_uk"],
        "A_w_uv": _A_in["w_uv"],
        "A_w_o": _A_in["w_o"],
        "B_x": _B_in["x"],
        "B_w_gate": _B_in["w_gate"],
        "B_w_up": _B_in["w_up"],
        "B_w_down": _B_in["w_down"],
    }

def reference(A_x, A_c_kv, A_w_q, A_w_uk, A_w_uv, A_w_o, B_x, B_w_gate, B_w_up, B_w_down):
    def _A_ref(x, c_kv, w_q, w_uk, w_uv, w_o):
        B, Sq, M = x.shape[0], x.shape[1], x.shape[2]
        Sk = c_kv.shape[1]
        H, D = w_q.shape[1], w_q.shape[2]
        q = torch.einsum("bqm,mhd->bhqd", x, w_q)
        k = torch.einsum("bkc,chd->bhkd", c_kv, w_uk)
        v = torch.einsum("bkc,chd->bhkd", c_kv, w_uv)
        scores = torch.einsum("bhqd,bhkd->bhqk", q, k) * (D ** -0.5)
        off = Sk - Sq
        qi = torch.arange(Sq)[:, None]
        kj = torch.arange(Sk)[None, :]
        cmask = kj <= (qi + off)
        scores = torch.where(cmask[None, None], scores, -1e9)
        p = _softmax(scores, axis=-1)
        ctx = torch.einsum("bhqk,bhkd->bhqd", p, v)
        return torch.einsum("bhqd,hdm->bqm", ctx, w_o)

    def _B_ref(x, w_gate, w_up, w_down):
        g = _silu(x @ w_gate)
        u = x @ w_up
        return (g * u) @ w_down

    x = A_x
    h = x + _A_ref(_layernorm(x, axis=-1), A_c_kv, A_w_q, A_w_uk, A_w_uv, A_w_o)
    h2 = h + _B_ref(_layernorm(h, axis=-1), B_w_gate, B_w_up, B_w_down)
    return h2
```

```asm
; @launch grid=(256,1,1) block=(512,1,1) lds=163840
.amdgcn_target "amdgcn-amd-amdhsa--gfx950"
.text
.globl sequential_preLN__compressed_kv_cla__swiglu_ffn__decode_kernel
.p2align 8
.type sequential_preLN__compressed_kv_cla__swiglu_ffn__decode_kernel,@function
sequential_preLN__compressed_kv_cla__swiglu_ffn__decode_kernel:
L_code_start:
    s_cmp_ge_u32 s2, 256
    s_cbranch_scc1 L_end
    s_load_dwordx16 s[16:31], s[0:1], 0
    s_load_dwordx8 s[32:39], s[0:1], 64
    s_load_dwordx2 s[40:41], s[0:1], 96
    v_lshrrev_b32 v2, 6, v0
    v_and_b32 v1, 63, v0
    v_readfirstlane_b32 s3, v2
    v_and_b32 v2, 15, v1
    v_lshrrev_b32 v3, 4, v1
    s_and_b32 s4, s2, 7
    s_lshr_b32 s5, s2, 3
    s_mov_b32 s65, 8192
    s_mov_b32 s66, 16384
    s_mov_b32 s67, 24576
    s_mov_b32 s68, 32768
    s_mov_b32 s69, 40960
    s_mov_b32 s70, 49152
    s_mov_b32 s71, 57344
    s_mov_b32 s13, 524288
    s_cmp_ge_u32 s5, 16
    s_cbranch_scc1 L_B
    s_mov_b32 s14, 0x05040100
    s_mov_b32 s15, 0x07060302
    s_lshl_b32 s9, s4, 4
    s_add_u32 s9, s9, s5
    s_lshr_b32 s6, s9, 2
    s_and_b32 s7, s9, 3
    s_mov_b32 s42, s6
    s_mov_b32 s43, s7
    s_cmp_ge_u32 s3, 4
    s_cbranch_scc1 L_Ahi
    v_lshrrev_b32 v4, 2, v2
    v_lshlrev_b32 v4, 10, v4
    v_and_b32 v5, 3, v1
    v_lshl_add_u32 v5, v3, 2, v5
    v_lshl_add_u32 v5, v5, 4, v4
    s_lshl_b32 s8, s43, 7
    s_lshl_b32 s10, s3, 5
    s_add_u32 s8, s8, s10
    s_lshl_b32 s10, s8, 1
    v_lshl_add_u32 v6, v3, 4, v4
    v_add_u32 v6, s10, v6
    s_lshl_b32 s10, s8, 13
    s_lshl_b32 s11, s42, 8
    s_add_u32 s10, s10, s11
    v_lshlrev_b32 v7, 16, v3
    v_lshl_add_u32 v7, v2, 4, v7
    v_add_u32 v7, s10, v7
    s_waitcnt lgkmcnt(0)
    s_mov_b32 s76, s20
    s_mov_b32 s77, s21
    s_mov_b32 s78, 4194304
    s_mov_b32 s79, 0x20000
    global_load_dwordx4 v[8:11], v5, s[16:17] offset:0
    global_load_dwordx4 v[12:15], v5, s[16:17] offset:256
    global_load_dwordx4 v[16:19], v5, s[16:17] offset:512
    global_load_dwordx4 v[20:23], v5, s[16:17] offset:768
    global_load_dwordx4 v[24:27], v6, s[16:17]
    buffer_load_dwordx4 v[32:35], v7, s[76:79], 0 offen
    buffer_load_dwordx4 v[36:39], v7, s[76:79], s65 offen
    buffer_load_dwordx4 v[40:43], v7, s[76:79], s66 offen
    buffer_load_dwordx4 v[44:47], v7, s[76:79], s67 offen
    buffer_load_dwordx4 v[48:51], v7, s[76:79], s68 offen
    buffer_load_dwordx4 v[52:55], v7, s[76:79], s69 offen
    buffer_load_dwordx4 v[56:59], v7, s[76:79], s70 offen
    buffer_load_dwordx4 v[60:63], v7, s[76:79], s71 offen
    s_load_dword s44, s[40:41], 0
    s_mov_b32 s72, s40
    s_mov_b32 s73, s41
    s_mov_b32 s74, 16777216
    s_mov_b32 s75, 0x20000
    s_mov_b32 s80, s24
    s_mov_b32 s81, s25
    s_mov_b32 s82, 4194304
    s_mov_b32 s83, 0x20000
    v_mov_b32 v28, 0
    v_mov_b32 v29, 0
    s_mov_b32 s10, 0x3f803f80
    s_waitcnt vmcnt(9)
    v_dot2c_f32_bf16 v28, s10, v8
    v_dot2c_f32_bf16 v29, v8, v8
    v_dot2c_f32_bf16 v28, s10, v9
    v_dot2c_f32_bf16 v29, v9, v9
    v_dot2c_f32_bf16 v28, s10, v10
    v_dot2c_f32_bf16 v29, v10, v10
    v_dot2c_f32_bf16 v28, s10, v11
    v_dot2c_f32_bf16 v29, v11, v11
    v_dot2c_f32_bf16 v28, s10, v12
    v_dot2c_f32_bf16 v29, v12, v12
    v_dot2c_f32_bf16 v28, s10, v13
    v_dot2c_f32_bf16 v29, v13, v13
    v_dot2c_f32_bf16 v28, s10, v14
    v_dot2c_f32_bf16 v29, v14, v14
    v_dot2c_f32_bf16 v28, s10, v15
    v_dot2c_f32_bf16 v29, v15, v15
    v_dot2c_f32_bf16 v28, s10, v16
    v_dot2c_f32_bf16 v29, v16, v16
    v_dot2c_f32_bf16 v28, s10, v17
    v_dot2c_f32_bf16 v29, v17, v17
    v_dot2c_f32_bf16 v28, s10, v18
    v_dot2c_f32_bf16 v29, v18, v18
    v_dot2c_f32_bf16 v28, s10, v19
    v_dot2c_f32_bf16 v29, v19, v19
    v_dot2c_f32_bf16 v28, s10, v20
    v_dot2c_f32_bf16 v29, v20, v20
    v_dot2c_f32_bf16 v28, s10, v21
    v_dot2c_f32_bf16 v29, v21, v21
    v_dot2c_f32_bf16 v28, s10, v22
    v_dot2c_f32_bf16 v29, v22, v22
    v_dot2c_f32_bf16 v28, s10, v23
    v_dot2c_f32_bf16 v29, v23, v23
    s_nop 1
    v_add_f32_dpp v28, v28, v28 quad_perm:[1,0,3,2] row_mask:0xf bank_mask:0xf
    v_add_f32_dpp v29, v29, v29 quad_perm:[1,0,3,2] row_mask:0xf bank_mask:0xf
    s_nop 0
    v_add_f32_dpp v28, v28, v28 quad_perm:[2,3,0,1] row_mask:0xf bank_mask:0xf
    v_add_f32_dpp v29, v29, v29 quad_perm:[2,3,0,1] row_mask:0xf bank_mask:0xf
    v_mov_b32 v30, v28
    s_nop 1
    v_permlane16_swap_b32 v28, v30
    v_add_f32 v28, v28, v30
    v_mov_b32 v31, v29
    s_nop 1
    v_permlane16_swap_b32 v29, v31
    v_add_f32 v29, v29, v31
    v_mov_b32 v30, v28
    s_nop 1
    v_permlane32_swap_b32 v28, v30
    v_add_f32 v28, v28, v30
    v_mov_b32 v31, v29
    s_nop 1
    v_permlane32_swap_b32 v29, v31
    v_add_f32 v29, v29, v31
    v_mul_f32 v28, 0x3b000000, v28
    v_mul_f32 v29, 0x3b000000, v29
    v_fma_f32 v29, -v28, v28, v29
    v_max_f32 v29, 0, v29
    v_add_f32 v29, 0x3727c5ac, v29
    v_rsq_f32 v29, v29
    s_waitcnt vmcnt(8)
    v_mul_f32 v28, v28, v29
    v_lshlrev_b32 v8, 16, v24
    v_and_b32 v9, 0xffff0000, v24
    v_lshlrev_b32 v10, 16, v25
    v_and_b32 v11, 0xffff0000, v25
    v_lshlrev_b32 v12, 16, v26
    v_and_b32 v13, 0xffff0000, v26
    v_lshlrev_b32 v14, 16, v27
    v_and_b32 v15, 0xffff0000, v27
    v_fma_f32 v8, v8, v29, -v28
    v_fma_f32 v9, v9, v29, -v28
    v_fma_f32 v10, v10, v29, -v28
    v_fma_f32 v11, v11, v29, -v28
    v_fma_f32 v12, v12, v29, -v28
    v_fma_f32 v13, v13, v29, -v28
    v_fma_f32 v14, v14, v29, -v28
    v_fma_f32 v15, v15, v29, -v28
    v_cvt_pk_bf16_f32 v24, v8, v9
    v_cvt_pk_bf16_f32 v25, v10, v11
    v_cvt_pk_bf16_f32 v26, v12, v13
    v_cvt_pk_bf16_f32 v27, v14, v15
    s_lshl_b32 s10, s3, 11
    v_lshlrev_b32 v8, 9, v3
    v_lshl_add_u32 v8, v2, 5, v8
    v_add_u32 v8, s10, v8
    v_and_b32 v9, 3, v1
    v_lshlrev_b32 v11, 4, v9
    v_lshlrev_b32 v9, 9, v9
    v_bfe_u32 v10, v1, 2, 2
    v_lshl_add_u32 v9, v10, 5, v9
    v_lshrrev_b32 v10, 5, v1
    v_lshl_add_u32 v9, v10, 7, v9
    s_lshl_b32 s10, s3, 8
    v_add_u32 v9, s10, v9
    v_and_b32 v10, 1, v3
    v_lshl_add_u32 v9, v10, 4, v9
    v_cmp_eq_u32 s[56:57], 1, v10
    s_lshl_b32 s10, s42, 13
    s_lshl_b32 s11, s3, 12
    s_add_u32 s10, s10, s11
    s_lshl_b32 s11, s43, 6
    s_add_u32 s10, s10, s11
    s_add_u32 s10, s10, 65536
    v_lshrrev_b32 v10, 2, v1
    v_lshl_add_u32 v11, v10, 8, v11
    v_add_u32 v11, s10, v11
    s_waitcnt lgkmcnt(0)
    s_add_u32 s44, s44, 1
    s_mul_i32 s48, s44, 0x9E3779B1
    s_xor_b32 s48, s48, 0x85EBCA6B
    s_mul_i32 s49, s44, 0xC2B2AE35
    s_add_u32 s49, s49, 0x27D4EB2F
    v_mov_b32 v12, s48
    v_mov_b32 v13, s49
    s_waitcnt vmcnt(6)
    v_perm_b32 v64, v36, v32, s14
    v_perm_b32 v68, v36, v32, s15
    v_perm_b32 v72, v37, v33, s14
    v_perm_b32 v76, v37, v33, s15
    v_perm_b32 v80, v38, v34, s14
    v_perm_b32 v84, v38, v34, s15
    v_perm_b32 v88, v39, v35, s14
    v_perm_b32 v92, v39, v35, s15
    s_waitcnt vmcnt(4)
    v_perm_b32 v65, v44, v40, s14
    v_perm_b32 v69, v44, v40, s15
    v_perm_b32 v73, v45, v41, s14
    v_perm_b32 v77, v45, v41, s15
    v_perm_b32 v81, v46, v42, s14
    v_perm_b32 v85, v46, v42, s15
    v_perm_b32 v89, v47, v43, s14
    v_perm_b32 v93, v47, v43, s15
    s_waitcnt vmcnt(2)
    v_perm_b32 v66, v52, v48, s14
    v_perm_b32 v70, v52, v48, s15
    v_perm_b32 v74, v53, v49, s14
    v_perm_b32 v78, v53, v49, s15
    v_perm_b32 v82, v54, v50, s14
    v_perm_b32 v86, v54, v50, s15
    v_perm_b32 v90, v55, v51, s14
    v_perm_b32 v94, v55, v51, s15
    s_waitcnt vmcnt(0)
    v_perm_b32 v67, v60, v56, s14
    v_perm_b32 v71, v60, v56, s15
    v_perm_b32 v75, v61, v57, s14
    v_perm_b32 v79, v61, v57, s15
    v_perm_b32 v83, v62, v58, s14
    v_perm_b32 v87, v62, v58, s15
    v_perm_b32 v91, v63, v59, s14
    v_perm_b32 v95, v63, v59, s15
    v_mfma_f32_16x16x32_bf16 v[96:99], v[24:27], v[64:67], 0
    v_mfma_f32_16x16x32_bf16 v[100:103], v[24:27], v[68:71], 0
    v_mfma_f32_16x16x32_bf16 v[104:107], v[24:27], v[72:75], 0
    v_mfma_f32_16x16x32_bf16 v[108:111], v[24:27], v[76:79], 0
    v_mfma_f32_16x16x32_bf16 v[112:115], v[24:27], v[80:83], 0
    v_mfma_f32_16x16x32_bf16 v[116:119], v[24:27], v[84:87], 0
    v_mfma_f32_16x16x32_bf16 v[120:123], v[24:27], v[88:91], 0
    v_mfma_f32_16x16x32_bf16 v[124:127], v[24:27], v[92:95], 0
    s_nop 1
    ds_write2_b32 v8, v96, v100 offset0:0 offset1:1
    s_nop 0
    ds_write2_b32 v8, v104, v108 offset0:2 offset1:3
    s_nop 0
    ds_write2_b32 v8, v112, v116 offset0:4 offset1:5
    s_nop 0
    ds_write2_b32 v8, v120, v124 offset0:6 offset1:7
    s_waitcnt lgkmcnt(0)
    s_barrier
    s_cmp_ge_u32 s3, 2
    s_cbranch_scc1 L_Alo_nopub
    ds_read_b128 v[32:35], v9 offset:0
    ds_read_b128 v[36:39], v9 offset:2048
    ds_read_b128 v[40:43], v9 offset:4096
    ds_read_b128 v[44:47], v9 offset:6144
    s_waitcnt lgkmcnt(2)
    v_add_f32 v32, v32, v36
    v_add_f32 v33, v33, v37
    v_add_f32 v34, v34, v38
    v_add_f32 v35, v35, v39
    s_waitcnt lgkmcnt(0)
    v_add_f32 v40, v40, v44
    v_add_f32 v41, v41, v45
    v_add_f32 v42, v42, v46
    v_add_f32 v43, v43, v47
    v_add_f32 v32, v32, v40
    v_add_f32 v33, v33, v41
    v_add_f32 v34, v34, v42
    v_add_f32 v35, v35, v43
    v_cvt_pk_bf16_f32 v36, v32, v33
    v_cvt_pk_bf16_f32 v37, v34, v35
    v_cndmask_b32 v16, v12, v36, s[56:57]
    v_cndmask_b32 v17, v13, v37, s[56:57]
    v_cndmask_b32 v18, v36, v12, s[56:57]
    v_cndmask_b32 v19, v37, v13, s[56:57]
    s_mov_b32 s10, 6225920
    buffer_store_dwordx4 v[16:19], v11, s[72:75], s10 offen
    buffer_store_dwordx4 v[16:19], v11, s[72:75], 0 offen sc1
L_Alo_nopub:
    s_barrier
    s_barrier
    s_lshl_b32 s10, s9, 7
    s_add_u32 s10, s10, 32768
    v_mov_b32 v16, s10
    s_mov_b64 exec, 0x1
Lcan_1:
    buffer_load_dwordx4 v[20:23], v16, s[72:75], 0 offen sc1
    s_waitcnt vmcnt(0)
    v_cmp_ne_u64 vcc, s[48:49], v[22:23]
    s_cbranch_vccz Lcand_2
    s_sleep 1
    s_sub_u32 s13, s13, 1
    s_cbranch_scc0 Lcan_1
    s_mov_b32 s13, 0
Lcand_2:
    s_mov_b64 exec, -1
    s_lshl_b32 s10, s7, 20
    s_lshl_b32 s11, s3, 18
    s_add_u32 s10, s10, s11
    s_lshl_b32 s11, s6, 8
    s_add_u32 s10, s10, s11
    v_lshlrev_b32 v7, 16, v3
    v_lshl_add_u32 v7, v2, 4, v7
    v_add_u32 v7, s10, v7
    buffer_load_dwordx4 v[128:131], v7, s[80:83], 0 offen
    buffer_load_dwordx4 v[132:135], v7, s[80:83], s65 offen
    buffer_load_dwordx4 v[136:139], v7, s[80:83], s66 offen
    buffer_load_dwordx4 v[140:143], v7, s[80:83], s67 offen
    buffer_load_dwordx4 v[144:147], v7, s[80:83], s68 offen
    buffer_load_dwordx4 v[148:151], v7, s[80:83], s69 offen
    buffer_load_dwordx4 v[152:155], v7, s[80:83], s70 offen
    buffer_load_dwordx4 v[156:159], v7, s[80:83], s71 offen
    s_waitcnt vmcnt(0)
    v_perm_b32 v160, v132, v128, s14
    v_perm_b32 v161, v140, v136, s14
    v_perm_b32 v162, v148, v144, s14
    v_perm_b32 v163, v156, v152, s14
    v_perm_b32 v164, v132, v128, s15
    v_perm_b32 v165, v140, v136, s15
    v_perm_b32 v166, v148, v144, s15
    v_perm_b32 v167, v156, v152, s15
    v_perm_b32 v168, v133, v129, s14
    v_perm_b32 v169, v141, v137, s14
    v_perm_b32 v170, v149, v145, s14
    v_perm_b32 v171, v157, v153, s14
    v_perm_b32 v172, v133, v129, s15
    v_perm_b32 v173, v141, v137, s15
    v_perm_b32 v174, v149, v145, s15
    v_perm_b32 v175, v157, v153, s15
    v_perm_b32 v176, v134, v130, s14
    v_perm_b32 v177, v142, v138, s14
    v_perm_b32 v178, v150, v146, s14
    v_perm_b32 v179, v158, v154, s14
    v_perm_b32 v180, v134, v130, s15
    v_perm_b32 v181, v142, v138, s15
    v_perm_b32 v182, v150, v146, s15
    v_perm_b32 v183, v158, v154, s15
    v_perm_b32 v184, v135, v131, s14
    v_perm_b32 v185, v143, v139, s14
    v_perm_b32 v186, v151, v147, s14
    v_perm_b32 v187, v159, v155, s14
    v_perm_b32 v188, v135, v131, s15
    v_perm_b32 v189, v143, v139, s15
    v_perm_b32 v190, v151, v147, s15
    v_perm_b32 v191, v159, v155, s15
    s_branch L_A_x
L_Ahi:
    s_sub_u32 s12, s3, 4
    s_lshl_b32 s8, s43, 7
    s_lshl_b32 s10, s12, 5
    s_add_u32 s8, s8, s10
    s_lshl_b32 s10, s8, 13
    s_lshl_b32 s11, s42, 8
    s_add_u32 s10, s10, s11
    s_mov_b32 s57, s10
    v_xor_b32 v7, v2, v3
    v_lshlrev_b32 v7, 4, v7
    v_lshl_add_u32 v30, v2, 8, v7
    v_lshl_add_u32 v7, v3, 13, v7
    s_lshl_b32 s11, s12, 13
    s_add_u32 s11, s11, 16384
    v_add_u32 v30, s11, v30
    s_getpc_b64 s[62:63]
L_pc:
    s_sub_u32 s62, s62, L_pc-L_code_start
    s_subb_u32 s63, s63, 0
    s_lshl_b32 s10, s12, 4
    s_add_u32 s10, s10, s5
    s_lshl_b32 s10, s10, 10
    v_lshlrev_b32 v4, 4, v1
    v_add_u32 v5, s10, v4
    v_min_u32 v5, L_code_end-L_code_start-16, v5
    global_load_dwordx4 v[8:11], v5, s[62:63]
    s_lshl_b32 s10, s42, 13
    s_add_u32 s10, s10, 6291456
    v_add_u32 v6, s10, v4
    v_subrev_u32 v27, 6225920, v6
    v_mov_b32 v26, v6
    s_waitcnt lgkmcnt(0)
    s_mov_b32 s76, s22
    s_mov_b32 s77, s23
    s_mov_b32 s78, 4194304
    s_mov_b32 s79, 0x20000
    s_mov_b32 s72, s40
    s_mov_b32 s73, s41
    s_mov_b32 s74, 16777216
    s_mov_b32 s75, 0x20000
    s_load_dword s44, s[40:41], 0
    s_mov_b32 s51, 4096
    s_add_u32 m0, s11, 0
    v_xor_b32 v28, 0, v7
    buffer_load_dwordx4 v28, s[76:79], s57 offen lds
    s_add_u32 s57, s57, 32768
    s_add_u32 m0, s11, 1024
    v_xor_b32 v29, 64, v7
    buffer_load_dwordx4 v29, s[76:79], s57 offen lds
    s_add_u32 s57, s57, 32768
    s_add_u32 m0, s11, 2048
    v_xor_b32 v28, 128, v7
    buffer_load_dwordx4 v28, s[76:79], s57 offen lds
    s_add_u32 s57, s57, 32768
    s_add_u32 m0, s11, 3072
    v_xor_b32 v29, 192, v7
    buffer_load_dwordx4 v29, s[76:79], s57 offen lds
    s_add_u32 s57, s57, 32768
    s_add_u32 m0, s11, 4096
    v_xor_b32 v28, 0, v7
    buffer_load_dwordx4 v28, s[76:79], s57 offen lds
    s_add_u32 s57, s57, 32768
    s_add_u32 m0, s11, 5120
    v_xor_b32 v29, 64, v7
    buffer_load_dwordx4 v29, s[76:79], s57 offen lds
    s_add_u32 s57, s57, 32768
    s_add_u32 m0, s11, 6144
    v_xor_b32 v28, 128, v7
    buffer_load_dwordx4 v28, s[76:79], s57 offen lds
    s_add_u32 s57, s57, 32768
    s_add_u32 m0, s11, 7168
    v_xor_b32 v29, 192, v7
    buffer_load_dwordx4 v29, s[76:79], s57 offen lds
    s_add_u32 s50, s12, s7
    s_and_b32 s50, s50, 3
    s_lshl_b32 s10, s9, 10
    s_lshl_b32 s56, s50, 8
    s_add_u32 s10, s10, s56
    s_add_u32 s10, s10, 1048576
    v_lshlrev_b32 v31, 17, v3
    v_lshl_add_u32 v31, v2, 4, v31
    v_add_u32 v31, s10, v31
    v_mov_b32 v12, -1
    v_mov_b32 v13, -1
    v_mov_b32 v14, -1
    v_mov_b32 v15, -1
    buffer_store_dwordx4 v[12:15], v31, s[72:75], 0 offen sc1
    s_cmp_eq_u32 s12, 0
    s_cbranch_scc0 L_Ahi_noh
    s_lshl_b32 s10, s9, 7
    s_add_u32 s10, s10, 16384
    v_add_u32 v5, s10, v4
    s_mov_b64 exec, 0xff
    buffer_store_dwordx4 v[12:15], v5, s[72:75], 0 offen sc1
    s_mov_b64 exec, -1
L_Ahi_noh:
    s_lshl_b32 s10, s42, 11
    s_lshl_b32 s56, s8, 2
    s_add_u32 s10, s10, s56
    s_add_u32 s10, s10, 524288
    v_and_b32 v16, 3, v2
    v_lshlrev_b32 v17, 16, v16
    v_lshrrev_b32 v18, 2, v2
    v_lshl_add_u32 v17, v18, 6, v17
    v_lshl_add_u32 v17, v3, 4, v17
    v_add_u32 v17, s10, v17
    v_cmp_eq_u32 s[58:59], 1, v18
    s_mov_b32 s80, s26
    s_mov_b32 s81, s27
    s_mov_b32 s82, 4194304
    s_mov_b32 s83, 0x20000
    s_lshl_b32 s10, s6, 17
    s_lshl_b32 s56, s50, 8
    s_add_u32 s10, s10, s56
    v_lshlrev_b32 v19, 13, v3
    v_lshl_add_u32 v19, v2, 4, v19
    v_add_u32 v19, s10, v19
    s_waitcnt lgkmcnt(0)
    s_add_u32 s44, s44, 1
    s_mul_i32 s48, s44, 0x9E3779B1
    s_xor_b32 s48, s48, 0x85EBCA6B
    s_mul_i32 s49, s44, 0xC2B2AE35
    s_add_u32 s49, s49, 0x27D4EB2F
    v_mov_b32 v22, s48
    v_mov_b32 v23, s49
    s_barrier
    s_waitcnt vmcnt(0)
    v_xor_b32 v28, 0, v30
    ds_read_b128 v[32:35], v28 offset:0
    ds_read_b128 v[48:51], v28 offset:4096
    v_xor_b32 v28, 64, v30
    ds_read_b128 v[36:39], v28 offset:0
    ds_read_b128 v[52:55], v28 offset:4096
    v_xor_b32 v28, 128, v30
    ds_read_b128 v[40:43], v28 offset:0
    ds_read_b128 v[56:59], v28 offset:4096
    v_xor_b32 v28, 192, v30
    ds_read_b128 v[44:47], v28 offset:0
    ds_read_b128 v[60:63], v28 offset:4096
    s_lshl_b32 s10, s12, 11
    s_lshl_b32 s11, s12, 10
    v_add_u32 v5, 8192, v4
    v_add_u32 v29, s11, v5
L_Ahi_poll:
    buffer_load_dwordx4 v[64:67], v6, s[72:75], s10 offen sc1
    buffer_load_dwordx4 v[68:71], v6, s[72:75], s10 offen offset:1024 sc1
    s_waitcnt vmcnt(1)
    v_cmp_ne_u64 s[60:61], s[48:49], v[64:65]
    s_waitcnt vmcnt(0)
    v_cmp_ne_u64 vcc, s[48:49], v[70:71]
    s_or_b64 s[60:61], s[60:61], vcc
    s_cbranch_scc0 L_Ahi_got
    s_and_b32 s56, s13, 7
    s_cmp_eq_u32 s56, 1
    s_cselect_b64 vcc, -1, 0
    v_cndmask_b32 v6, v26, v27, vcc
    s_sub_u32 s13, s13, 1
    s_cbranch_scc0 L_Ahi_poll
    s_mov_b32 s13, 0
L_Ahi_got:
    ds_write_b128 v29, v[66:69]
    s_waitcnt lgkmcnt(0)
    s_barrier
    ds_read_b128 v[72:75], v5 offset:0
    ds_read_b128 v[76:79], v5 offset:1024
    ds_read_b128 v[80:83], v5 offset:2048
    ds_read_b128 v[84:87], v5 offset:3072
    s_waitcnt lgkmcnt(3)
    v_mfma_f32_16x16x32_bf16 v[96:99], v[32:35], v[72:75], 0
    v_mfma_f32_16x16x32_bf16 v[100:103], v[48:51], v[72:75], 0
    s_waitcnt lgkmcnt(2)
    v_mfma_f32_16x16x32_bf16 v[96:99], v[36:39], v[76:79], v[96:99]
    v_mfma_f32_16x16x32_bf16 v[100:103], v[52:55], v[76:79], v[100:103]
    s_waitcnt lgkmcnt(1)
    v_mfma_f32_16x16x32_bf16 v[96:99], v[40:43], v[80:83], v[96:99]
    v_mfma_f32_16x16x32_bf16 v[100:103], v[56:59], v[80:83], v[100:103]
    s_waitcnt lgkmcnt(0)
    v_mfma_f32_16x16x32_bf16 v[96:99], v[44:47], v[84:87], v[96:99]
    v_mfma_f32_16x16x32_bf16 v[100:103], v[60:63], v[84:87], v[100:103]
    s_nop 6
    v_add_f32_dpp v96, v96, v96 row_ror:4 row_mask:0xf bank_mask:0xf
    v_add_f32_dpp v97, v97, v97 row_ror:4 row_mask:0xf bank_mask:0xf
    v_add_f32_dpp v98, v98, v98 row_ror:4 row_mask:0xf bank_mask:0xf
    v_add_f32_dpp v99, v99, v99 row_ror:4 row_mask:0xf bank_mask:0xf
    v_add_f32_dpp v100, v100, v100 row_ror:4 row_mask:0xf bank_mask:0xf
    v_add_f32_dpp v101, v101, v101 row_ror:4 row_mask:0xf bank_mask:0xf
    v_add_f32_dpp v102, v102, v102 row_ror:4 row_mask:0xf bank_mask:0xf
    v_add_f32_dpp v103, v103, v103 row_ror:4 row_mask:0xf bank_mask:0xf
    v_add_f32_dpp v96, v96, v96 row_ror:8 row_mask:0xf bank_mask:0xf
    v_add_f32_dpp v97, v97, v97 row_ror:8 row_mask:0xf bank_mask:0xf
    v_add_f32_dpp v98, v98, v98 row_ror:8 row_mask:0xf bank_mask:0xf
    v_add_f32_dpp v99, v99, v99 row_ror:8 row_mask:0xf bank_mask:0xf
    v_add_f32_dpp v100, v100, v100 row_ror:8 row_mask:0xf bank_mask:0xf
    v_add_f32_dpp v101, v101, v101 row_ror:8 row_mask:0xf bank_mask:0xf
    v_add_f32_dpp v102, v102, v102 row_ror:8 row_mask:0xf bank_mask:0xf
    v_add_f32_dpp v103, v103, v103 row_ror:8 row_mask:0xf bank_mask:0xf
    v_cndmask_b32 v24, v96, v100, s[58:59]
    v_cndmask_b32 v25, v97, v101, s[58:59]
    v_cndmask_b32 v26, v98, v102, s[58:59]
    v_cndmask_b32 v27, v99, v103, s[58:59]
    v_mul_f32 v24, 0x3e0293ee, v24
    v_mul_f32 v25, 0x3e0293ee, v25
    v_mul_f32 v26, 0x3e0293ee, v26
    v_mul_f32 v27, 0x3e0293ee, v27
    v_cvt_pk_bf16_f32 v20, v24, v25
    v_cvt_pk_bf16_f32 v21, v26, v27
    s_mov_b32 exec_lo, 0x00ff00ff
    s_mov_b32 exec_hi, 0x00ff00ff
    buffer_store_dwordx4 v[20:23], v17, s[72:75], 0 offen sc1
    s_mov_b64 exec, -1
    s_barrier
    s_add_u32 s56, s7, 0
    s_and_b32 s56, s56, 3
    s_lshl_b32 s52, s56, 6
    s_lshl_b32 s56, s56, 15
    buffer_load_dwordx4 v[128:131], v19, s[80:83], s56 offen offset:0
    buffer_load_dwordx4 v[132:135], v19, s[80:83], s56 offen offset:1024
    buffer_load_dwordx4 v[136:139], v19, s[80:83], s56 offen offset:2048
    buffer_load_dwordx4 v[140:143], v19, s[80:83], s56 offen offset:3072
    s_add_u32 s56, s56, 4096
    buffer_load_dwordx4 v[144:147], v19, s[80:83], s56 offen offset:0
    buffer_load_dwordx4 v[148:151], v19, s[80:83], s56 offen offset:1024
    buffer_load_dwordx4 v[152:155], v19, s[80:83], s56 offen offset:2048
    buffer_load_dwordx4 v[156:159], v19, s[80:83], s56 offen offset:3072
    s_add_u32 s56, s7, 1
    s_and_b32 s56, s56, 3
    s_lshl_b32 s53, s56, 6
    s_lshl_b32 s56, s56, 15
    buffer_load_dwordx4 v[160:163], v19, s[80:83], s56 offen offset:0
    buffer_load_dwordx4 v[164:167], v19, s[80:83], s56 offen offset:1024
    buffer_load_dwordx4 v[168:171], v19, s[80:83], s56 offen offset:2048
    buffer_load_dwordx4 v[172:175], v19, s[80:83], s56 offen offset:3072
    s_add_u32 s56, s56, 4096
    buffer_load_dwordx4 v[176:179], v19, s[80:83], s56 offen offset:0
    buffer_load_dwordx4 v[180:183], v19, s[80:83], s56 offen offset:1024
    buffer_load_dwordx4 v[184:187], v19, s[80:83], s56 offen offset:2048
    buffer_load_dwordx4 v[188:191], v19, s[80:83], s56 offen offset:3072
    s_add_u32 s56, s7, 2
    s_and_b32 s56, s56, 3
    s_lshl_b32 s54, s56, 6
    s_lshl_b32 s56, s56, 15
    buffer_load_dwordx4 v[192:195], v19, s[80:83], s56 offen offset:0
    buffer_load_dwordx4 v[196:199], v19, s[80:83], s56 offen offset:1024
    buffer_load_dwordx4 v[200:203], v19, s[80:83], s56 offen offset:2048
    buffer_load_dwordx4 v[204:207], v19, s[80:83], s56 offen offset:3072
    s_add_u32 s56, s56, 4096
    buffer_load_dwordx4 v[208:211], v19, s[80:83], s56 offen offset:0
    buffer_load_dwordx4 v[212:215], v19, s[80:83], s56 offen offset:1024
    buffer_load_dwordx4 v[216:219], v19, s[80:83], s56 offen offset:2048
    buffer_load_dwordx4 v[220:223], v19, s[80:83], s56 offen offset:3072
    s_add_u32 s56, s7, 3
    s_and_b32 s56, s56, 3
    s_lshl_b32 s55, s56, 6
    s_lshl_b32 s56, s56, 15
    buffer_load_dwordx4 v[224:227], v19, s[80:83], s56 offen offset:0
    buffer_load_dwordx4 v[228:231], v19, s[80:83], s56 offen offset:1024
    buffer_load_dwordx4 v[232:235], v19, s[80:83], s56 offen offset:2048
    buffer_load_dwordx4 v[236:239], v19, s[80:83], s56 offen offset:3072
    s_add_u32 s56, s56, 4096
    buffer_load_dwordx4 v[240:243], v19, s[80:83], s56 offen offset:0
    buffer_load_dwordx4 v[244:247], v19, s[80:83], s56 offen offset:1024
    buffer_load_dwordx4 v[248:251], v19, s[80:83], s56 offen offset:2048
    buffer_load_dwordx4 v[252:255], v19, s[80:83], s56 offen offset:3072
    s_waitcnt vmcnt(24)
    v_perm_b32 v96, v132, v128, s14
    v_perm_b32 v97, v140, v136, s14
    v_perm_b32 v98, v148, v144, s14
    v_perm_b32 v99, v156, v152, s14
    v_perm_b32 v100, v132, v128, s15
    v_perm_b32 v101, v140, v136, s15
    v_perm_b32 v102, v148, v144, s15
    v_perm_b32 v103, v156, v152, s15
    v_perm_b32 v104, v133, v129, s14
    v_perm_b32 v105, v141, v137, s14
    v_perm_b32 v106, v149, v145, s14
    v_perm_b32 v107, v157, v153, s14
    v_perm_b32 v108, v133, v129, s15
    v_perm_b32 v109, v141, v137, s15
    v_perm_b32 v110, v149, v145, s15
    v_perm_b32 v111, v157, v153, s15
    v_perm_b32 v112, v134, v130, s14
    v_perm_b32 v113, v142, v138, s14
    v_perm_b32 v114, v150, v146, s14
    v_perm_b32 v115, v158, v154, s14
    v_perm_b32 v116, v134, v130, s15
    v_perm_b32 v117, v142, v138, s15
    v_perm_b32 v118, v150, v146, s15
    v_perm_b32 v119, v158, v154, s15
    v_perm_b32 v120, v135, v131, s14
    v_perm_b32 v121, v143, v139, s14
    v_perm_b32 v122, v151, v147, s14
    v_perm_b32 v123, v159, v155, s14
    v_perm_b32 v124, v135, v131, s15
    v_perm_b32 v125, v143, v139, s15
    v_perm_b32 v126, v151, v147, s15
    v_perm_b32 v127, v159, v155, s15
    s_waitcnt vmcnt(16)
    v_perm_b32 v128, v164, v160, s14
    v_perm_b32 v129, v172, v168, s14
    v_perm_b32 v130, v180, v176, s14
    v_perm_b32 v131, v188, v184, s14
    v_perm_b32 v132, v164, v160, s15
    v_perm_b32 v133, v172, v168, s15
    v_perm_b32 v134, v180, v176, s15
    v_perm_b32 v135, v188, v184, s15
    v_perm_b32 v136, v165, v161, s14
    v_perm_b32 v137, v173, v169, s14
    v_perm_b32 v138, v181, v177, s14
    v_perm_b32 v139, v189, v185, s14
    v_perm_b32 v140, v165, v161, s15
    v_perm_b32 v141, v173, v169, s15
    v_perm_b32 v142, v181, v177, s15
    v_perm_b32 v143, v189, v185, s15
    v_perm_b32 v144, v166, v162, s14
    v_perm_b32 v145, v174, v170, s14
    v_perm_b32 v146, v182, v178, s14
    v_perm_b32 v147, v190, v186, s14
    v_perm_b32 v148, v166, v162, s15
    v_perm_b32 v149, v174, v170, s15
    v_perm_b32 v150, v182, v178, s15
    v_perm_b32 v151, v190, v186, s15
    v_perm_b32 v152, v167, v163, s14
    v_perm_b32 v153, v175, v171, s14
    v_perm_b32 v154, v183, v179, s14
    v_perm_b32 v155, v191, v187, s14
    v_perm_b32 v156, v167, v163, s15
    v_perm_b32 v157, v175, v171, s15
    v_perm_b32 v158, v183, v179, s15
    v_perm_b32 v159, v191, v187, s15
    s_waitcnt vmcnt(8)
    v_perm_b32 v160, v196, v192, s14
    v_perm_b32 v161, v204, v200, s14
    v_perm_b32 v162, v212, v208, s14
    v_perm_b32 v163, v220, v216, s14
    v_perm_b32 v164, v196, v192, s15
    v_perm_b32 v165, v204, v200, s15
    v_perm_b32 v166, v212, v208, s15
    v_perm_b32 v167, v220, v216, s15
    v_perm_b32 v168, v197, v193, s14
    v_perm_b32 v169, v205, v201, s14
    v_perm_b32 v170, v213, v209, s14
    v_perm_b32 v171, v221, v217, s14
    v_perm_b32 v172, v197, v193, s15
    v_perm_b32 v173, v205, v201, s15
    v_perm_b32 v174, v213, v209, s15
    v_perm_b32 v175, v221, v217, s15
    v_perm_b32 v176, v198, v194, s14
    v_perm_b32 v177, v206, v202, s14
    v_perm_b32 v178, v214, v210, s14
    v_perm_b32 v179, v222, v218, s14
    v_perm_b32 v180, v198, v194, s15
    v_perm_b32 v181, v206, v202, s15
    v_perm_b32 v182, v214, v210, s15
    v_perm_b32 v183, v222, v218, s15
    v_perm_b32 v184, v199, v195, s14
    v_perm_b32 v185, v207, v203, s14
    v_perm_b32 v186, v215, v211, s14
    v_perm_b32 v187, v223, v219, s14
    v_perm_b32 v188, v199, v195, s15
    v_perm_b32 v189, v207, v203, s15
    v_perm_b32 v190, v215, v211, s15
    v_perm_b32 v191, v223, v219, s15
    s_waitcnt vmcnt(0)
    v_perm_b32 v192, v228, v224, s14
    v_perm_b32 v193, v236, v232, s14
    v_perm_b32 v194, v244, v240, s14
    v_perm_b32 v195, v252, v248, s14
    v_perm_b32 v196, v228, v224, s15
    v_perm_b32 v197, v236, v232, s15
    v_perm_b32 v198, v244, v240, s15
    v_perm_b32 v199, v252, v248, s15
    v_perm_b32 v200, v229, v225, s14
    v_perm_b32 v201, v237, v233, s14
    v_perm_b32 v202, v245, v241, s14
    v_perm_b32 v203, v253, v249, s14
    v_perm_b32 v204, v229, v225, s15
    v_perm_b32 v205, v237, v233, s15
    v_perm_b32 v206, v245, v241, s15
    v_perm_b32 v207, v253, v249, s15
    v_perm_b32 v208, v230, v226, s14
    v_perm_b32 v209, v238, v234, s14
    v_perm_b32 v210, v246, v242, s14
    v_perm_b32 v211, v254, v250, s14
    v_perm_b32 v212, v230, v226, s15
    v_perm_b32 v213, v238, v234, s15
    v_perm_b32 v214, v246, v242, s15
    v_perm_b32 v215, v254, v250, s15
    v_perm_b32 v216, v231, v227, s14
    v_perm_b32 v217, v239, v235, s14
    v_perm_b32 v218, v247, v243, s14
    v_perm_b32 v219, v255, v251, s14
    v_perm_b32 v220, v231, v227, s15
    v_perm_b32 v221, v239, v235, s15
    v_perm_b32 v222, v247, v243, s15
    v_perm_b32 v223, v255, v251, s15
L_A_x:
    s_lshl_b32 s10, s9, 15
    s_lshl_b32 s56, s3, 12
    s_add_u32 s10, s10, s56
    s_add_u32 s10, s10, 2097152
    v_lshlrev_b32 v5, 4, v1
    v_add_u32 v5, s10, v5
    s_lshr_b32 s10, s3, 1
    s_lshl_b32 s10, s10, 14
    s_lshl_b32 s56, s6, 4
    s_add_u32 s10, s10, s56
    s_add_u32 s10, s10, 786432
    v_and_b32 v4, 31, v1
    v_lshlrev_b32 v4, 9, v4
    v_add_u32 v4, s10, v4
    v_and_b32 v8, 1, v2
    v_lshlrev_b32 v8, 4, v8
    v_mov_b32 v9, 0xffff
    v_lshlrev_b32 v8, v8, v9
    v_lshrrev_b32 v9, 1, v2
    v_cmp_eq_u32 vcc, 0, v9
    s_nop 1
    v_cndmask_b32 v64, 0, v8, vcc
    v_cmp_eq_u32 vcc, 1, v9
    s_nop 1
    v_cndmask_b32 v65, 0, v8, vcc
    v_cmp_eq_u32 vcc, 2, v9
    s_nop 1
    v_cndmask_b32 v66, 0, v8, vcc
    v_cmp_eq_u32 vcc, 3, v9
    s_nop 1
    v_cndmask_b32 v67, 0, v8, vcc
    s_and_b32 s10, s3, 1
    s_lshl_b32 s10, s10, 6
    v_lshlrev_b32 v6, 2, v3
    v_add_u32 v6, s10, v6
    s_mul_i32 s10, s3, 272
    v_lshlrev_b32 v8, 4, v2
    v_lshl_add_u32 v8, v3, 3, v8
    v_add_u32 v8, s10, v8
    v_lshrrev_b32 v9, 2, v2
    v_and_b32 v10, 1, v2
    v_lshl_add_u32 v9, v9, 1, v10
    v_mul_u32_u24 v9, 272, v9
    v_lshl_add_u32 v9, v3, 4, v9
    s_lshl_b32 s56, s3, 6
    v_add_u32 v9, s56, v9
    v_mul_u32_u24 v10, 1088, v3
    v_lshl_add_u32 v10, v2, 4, v10
    s_add_u32 s10, s10, 4096
    v_add_u32 v10, s10, v10
    v_mul_u32_u24 v11, 272, v2
    v_lshl_add_u32 v11, v3, 4, v11
    v_add_u32 v11, 4096, v11
    s_lshl_b32 s10, s7, 14
    s_lshl_b32 s56, s3, 11
    s_add_u32 s10, s10, s56
    s_add_u32 s10, s10, 917504
    v_lshlrev_b32 v7, 7, v2
    v_add_u32 v7, s10, v7
    buffer_load_dwordx4 v[72:75], v4, s[72:75], 0 offen sc1
    s_mov_b64 exec, 0x1
Lcan_3:
    buffer_load_dwordx4 v[72:75], v4, s[72:75], 0 offen sc1
    s_waitcnt vmcnt(0)
    v_cmp_ne_u64 vcc, s[48:49], v[74:75]
    s_cbranch_vccz Lcand_4
    s_sleep 1
    s_sub_u32 s13, s13, 1
    s_cbranch_scc0 Lcan_3
    s_mov_b32 s13, 0
Lcand_4:
    s_mov_b64 exec, -1
    s_mov_b64 exec, -1
Lmp_5:
    buffer_load_dwordx4 v[72:75], v4, s[72:75], 0 offen sc1
    s_waitcnt vmcnt(0)
    v_cmp_ne_u64 vcc, s[48:49], v[74:75]
    s_and_b64 exec, exec, vcc
    s_cbranch_scc0 Lmpd_6
    s_sub_u32 s13, s13, 1
    s_cbranch_scc0 Lmp_5
    s_mov_b32 s13, 0
Lmpd_6:
    s_mov_b64 exec, -1
    buffer_load_dwordx4 v[32:35], v5, s[72:75], 0 offen offset:0 sc1
    buffer_load_dwordx4 v[36:39], v5, s[72:75], 0 offen offset:1024 sc1
    buffer_load_dwordx4 v[40:43], v5, s[72:75], 0 offen offset:2048 sc1
    buffer_load_dwordx4 v[44:47], v5, s[72:75], 0 offen offset:3072 sc1
    v_mov_b32 v12, v72
    s_nop 1
    v_max_f32_dpp v12, v12, v12 row_ror:1 row_mask:0xf bank_mask:0xf
    s_nop 1
    v_max_f32_dpp v12, v12, v12 row_ror:2 row_mask:0xf bank_mask:0xf
    s_nop 1
    v_max_f32_dpp v12, v12, v12 row_ror:4 row_mask:0xf bank_mask:0xf
    s_nop 1
    v_max_f32_dpp v12, v12, v12 row_ror:8 row_mask:0xf bank_mask:0xf
    v_mov_b32 v13, v12
    s_nop 1
    v_permlane16_swap_b32 v12, v13
    v_max_f32 v12, v12, v13
    v_sub_f32 v12, v72, v12
    v_exp_f32 v12, v12
    s_nop 0
    v_cvt_pk_bf16_f32 v12, v12, v12
    ds_bpermute_b32 v16, v6, v12 offset:0
    ds_bpermute_b32 v17, v6, v12 offset:16
    ds_bpermute_b32 v18, v6, v12 offset:32
    ds_bpermute_b32 v19, v6, v12 offset:48
    v_and_b32 v13, 0xffff0000, v12
    v_mul_f32 v13, v13, v73
    s_nop 1
    v_add_f32_dpp v13, v13, v13 row_ror:1 row_mask:0xf bank_mask:0xf
    s_nop 1
    v_add_f32_dpp v13, v13, v13 row_ror:2 row_mask:0xf bank_mask:0xf
    s_nop 1
    v_add_f32_dpp v13, v13, v13 row_ror:4 row_mask:0xf bank_mask:0xf
    s_nop 1
    v_add_f32_dpp v13, v13, v13 row_ror:8 row_mask:0xf bank_mask:0xf
    v_mov_b32 v14, v13
    s_nop 1
    v_permlane16_swap_b32 v13, v14
    v_add_f32 v13, v13, v14
    v_rcp_f32 v13, v13
    s_waitcnt lgkmcnt(3)
    v_and_b32 v48, v16, v64
    v_and_b32 v49, v16, v65
    v_and_b32 v50, v16, v66
    v_and_b32 v51, v16, v67
    s_waitcnt lgkmcnt(2)
    v_and_b32 v52, v17, v64
    v_and_b32 v53, v17, v65
    v_and_b32 v54, v17, v66
    v_and_b32 v55, v17, v67
    s_waitcnt lgkmcnt(1)
    v_and_b32 v56, v18, v64
    v_and_b32 v57, v18, v65
    v_and_b32 v58, v18, v66
    v_and_b32 v59, v18, v67
    s_waitcnt lgkmcnt(0)
    v_and_b32 v60, v19, v64
    v_and_b32 v61, v19, v65
    v_and_b32 v62, v19, v66
    v_and_b32 v63, v19, v67
    s_waitcnt vmcnt(3)
    v_mfma_f32_16x16x32_bf16 v[68:71], v[48:51], v[32:35], 0
    s_waitcnt vmcnt(2)
    v_mfma_f32_16x16x32_bf16 v[68:71], v[52:55], v[36:39], v[68:71]
    s_waitcnt vmcnt(1)
    v_mfma_f32_16x16x32_bf16 v[68:71], v[56:59], v[40:43], v[68:71]
    s_waitcnt vmcnt(0)
    v_mfma_f32_16x16x32_bf16 v[68:71], v[60:63], v[44:47], v[68:71]
    s_nop 7
    v_mul_f32 v68, v68, v13
    v_mul_f32 v69, v69, v13
    v_mul_f32 v70, v70, v13
    v_mul_f32 v71, v71, v13
    v_cvt_pk_bf16_f32 v14, v68, v69
    v_cvt_pk_bf16_f32 v15, v70, v71
    s_mov_b32 exec_hi, 0
    ds_write_b64 v8, v[14:15]
    s_mov_b64 exec, -1
    s_waitcnt lgkmcnt(0)
    s_barrier
    s_cmp_ge_u32 s3, 4
    s_cbranch_scc1 L_A_x3
    ds_read_b128 v[16:19], v9
    s_waitcnt lgkmcnt(0)
    v_mfma_f32_16x16x32_bf16 v[96:99], v[16:19], v[160:163], 0
    v_mfma_f32_16x16x32_bf16 v[100:103], v[16:19], v[164:167], 0
    v_mfma_f32_16x16x32_bf16 v[104:107], v[16:19], v[168:171], 0
    v_mfma_f32_16x16x32_bf16 v[108:111], v[16:19], v[172:175], 0
    v_mfma_f32_16x16x32_bf16 v[112:115], v[16:19], v[176:179], 0
    v_mfma_f32_16x16x32_bf16 v[116:119], v[16:19], v[180:183], 0
    v_mfma_f32_16x16x32_bf16 v[120:123], v[16:19], v[184:187], 0
    v_mfma_f32_16x16x32_bf16 v[124:127], v[16:19], v[188:191], 0
    s_nop 0
    v_add_f32 v96, v96, v97
    v_add_f32 v100, v100, v101
    v_add_f32 v104, v104, v105
    v_add_f32 v108, v108, v109
    v_add_f32 v112, v112, v113
    v_add_f32 v116, v116, v117
    v_add_f32 v120, v120, v121
    v_add_f32 v124, v124, v125
    v_cvt_pk_bf16_f32 v20, v96, v100
    v_cvt_pk_bf16_f32 v21, v104, v108
    v_cvt_pk_bf16_f32 v22, v112, v116
    v_cvt_pk_bf16_f32 v23, v120, v124
    ds_write_b128 v10, v[20:23]
    s_waitcnt lgkmcnt(0)
    s_barrier
    s_cmp_eq_u32 s3, 0
    s_cbranch_scc0 L_end
    s_branch L_A_fin
L_A_x3:
    v_add_u32 v24, s52, v11
    v_add_u32 v25, s53, v11
    v_add_u32 v26, s54, v11
    v_add_u32 v27, s55, v11
    s_barrier
    ds_read_b128 v[32:35], v24
    ds_read_b128 v[36:39], v25
    ds_read_b128 v[40:43], v26
    ds_read_b128 v[44:47], v27
    s_waitcnt lgkmcnt(3)
    v_mfma_f32_16x16x32_bf16 v[224:227], v[32:35], v[96:99], 0
    v_mfma_f32_16x16x32_bf16 v[228:231], v[32:35], v[100:103], 0
    v_mfma_f32_16x16x32_bf16 v[232:235], v[32:35], v[104:107], 0
    v_mfma_f32_16x16x32_bf16 v[236:239], v[32:35], v[108:111], 0
    v_mfma_f32_16x16x32_bf16 v[240:243], v[32:35], v[112:115], 0
    v_mfma_f32_16x16x32_bf16 v[244:247], v[32:35], v[116:119], 0
    v_mfma_f32_16x16x32_bf16 v[248:251], v[32:35], v[120:123], 0
    v_mfma_f32_16x16x32_bf16 v[252:255], v[32:35], v[124:127], 0
    s_waitcnt lgkmcnt(2)
    v_mfma_f32_16x16x32_bf16 v[224:227], v[36:39], v[128:131], v[224:227]
    v_mfma_f32_16x16x32_bf16 v[228:231], v[36:39], v[132:135], v[228:231]
    v_mfma_f32_16x16x32_bf16 v[232:235], v[36:39], v[136:139], v[232:235]
    v_mfma_f32_16x16x32_bf16 v[236:239], v[36:39], v[140:143], v[236:239]
    v_mfma_f32_16x16x32_bf16 v[240:243], v[36:39], v[144:147], v[240:243]
    v_mfma_f32_16x16x32_bf16 v[244:247], v[36:39], v[148:151], v[244:247]
    v_mfma_f32_16x16x32_bf16 v[248:251], v[36:39], v[152:155], v[248:251]
    v_mfma_f32_16x16x32_bf16 v[252:255], v[36:39], v[156:159], v[252:255]
    s_waitcnt lgkmcnt(0)
    v_mfma_f32_16x16x32_bf16 v[224:227], v[40:43], v[160:163], v[224:227]
    v_mfma_f32_16x16x32_bf16 v[224:227], v[44:47], v[192:195], v[224:227]
    v_mfma_f32_16x16x32_bf16 v[228:231], v[40:43], v[164:167], v[228:231]
    v_mfma_f32_16x16x32_bf16 v[228:231], v[44:47], v[196:199], v[228:231]
    v_mfma_f32_16x16x32_bf16 v[232:235], v[40:43], v[168:171], v[232:235]
    v_mfma_f32_16x16x32_bf16 v[232:235], v[44:47], v[200:203], v[232:235]
    s_nop 3
    v_add_f32 v224, v224, v225
    v_add_f32 v226, v226, v227
    v_add_f32 v224, v224, v226
    v_mfma_f32_16x16x32_bf16 v[236:239], v[40:43], v[172:175], v[236:239]
    v_mfma_f32_16x16x32_bf16 v[236:239], v[44:47], v[204:207], v[236:239]
    v_add_f32 v228, v228, v229
    v_add_f32 v230, v230, v231
    v_add_f32 v228, v228, v230
    v_cvt_pk_bf16_f32 v20, v224, v228
    v_mfma_f32_16x16x32_bf16 v[240:243], v[40:43], v[176:179], v[240:243]
    v_mfma_f32_16x16x32_bf16 v[240:243], v[44:47], v[208:211], v[240:243]
    v_add_f32 v232, v232, v233
    v_add_f32 v234, v234, v235
    v_add_f32 v232, v232, v234
    v_mfma_f32_16x16x32_bf16 v[244:247], v[40:43], v[180:183], v[244:247]
    v_mfma_f32_16x16x32_bf16 v[244:247], v[44:47], v[212:215], v[244:247]
    v_add_f32 v236, v236, v237
    v_add_f32 v238, v238, v239
    v_add_f32 v236, v236, v238
    v_cvt_pk_bf16_f32 v21, v232, v236
    v_mfma_f32_16x16x32_bf16 v[248:251], v[40:43], v[184:187], v[248:251]
    v_mfma_f32_16x16x32_bf16 v[248:251], v[44:47], v[216:219], v[248:251]
    v_add_f32 v240, v240, v241
    v_add_f32 v242, v242, v243
    v_add_f32 v240, v240, v242
    v_mfma_f32_16x16x32_bf16 v[252:255], v[40:43], v[188:191], v[252:255]
    v_mfma_f32_16x16x32_bf16 v[252:255], v[44:47], v[220:223], v[252:255]
    v_add_f32 v244, v244, v245
    v_add_f32 v246, v246, v247
    v_add_f32 v244, v244, v246
    v_cvt_pk_bf16_f32 v22, v240, v244
    v_add_f32 v248, v248, v249
    v_add_f32 v250, v250, v251
    v_add_f32 v248, v248, v250
    s_nop 0
    v_add_f32 v252, v252, v253
    v_add_f32 v254, v254, v255
    v_add_f32 v252, v252, v254
    v_cvt_pk_bf16_f32 v23, v248, v252
    buffer_store_dwordx4 v[20:23], v31, s[72:75], 0 offen sc1
    s_endpgm
L_A_fin:
    s_lshl_b32 s10, s7, 10
    s_lshl_b32 s56, s6, 5
    s_add_u32 s10, s10, s56
    v_lshrrev_b32 v4, 1, v2
    v_lshl_add_u32 v4, v3, 3, v4
    v_and_b32 v5, 1, v2
    v_lshlrev_b32 v5, 4, v5
    v_lshl_add_u32 v6, v3, 3, v5
    v_add_u32 v6, s10, v6
    s_add_u32 s11, s10, 1572864
    v_lshl_add_u32 v8, v4, 12, v5
    v_add_u32 v8, s11, v8
    v_add_u32 v9, 262144, v8
    s_lshl_b32 s10, s10, 2
    s_add_u32 s10, s10, 16384
    v_add_u32 v10, s10, v5
    v_cmp_eq_u32 vcc, 22, v4
    s_nop 1
    v_cndmask_b32 v9, v9, v10, vcc
    v_cmp_ge_u32 s[56:57], 22, v4
    v_mov_b32 v40, 0
    v_and_b32 v16, 0x3f803f80, v64
    v_mov_b32 v41, 0
    v_and_b32 v17, 0x3f803f80, v65
    v_mov_b32 v42, 0
    v_and_b32 v18, 0x3f803f80, v66
    v_mov_b32 v43, 0
    v_and_b32 v19, 0x3f803f80, v67
    s_mov_b32 s11, 131072
    s_mov_b32 s76, s36
    s_mov_b32 s77, s37
    s_mov_b32 s78, 4096
    s_mov_b32 s79, 0x20000
    s_mov_b64 exec, 0x1
Lcan_7:
    buffer_load_dwordx4 v[32:35], v8, s[72:75], 0 offen sc1
    s_waitcnt vmcnt(0)
    v_cmp_eq_u32 vcc, -1, v32
    s_cbranch_vccz Lcand_8
    s_sleep 1
    s_sub_u32 s13, s13, 1
    s_cbranch_scc0 Lcan_7
    s_mov_b32 s13, 0
Lcand_8:
    s_mov_b64 exec, -1
Lsp_9:
    buffer_load_dwordx4 v[32:35], v8, s[72:75], 0 offen sc1
    buffer_load_dwordx4 v[36:39], v8, s[72:75], s11 offen sc1
    s_mov_b64 exec, s[56:57]
    buffer_load_dwordx4 v[40:43], v9, s[72:75], 0 offen sc1
    s_mov_b64 exec, -1
    s_waitcnt vmcnt(0)
    v_max3_u32 v7, v32, v33, v34
    v_max3_u32 v7, v7, v35, v36
    v_max3_u32 v7, v7, v37, v38
    v_max3_u32 v7, v7, v39, v40
    v_max3_u32 v7, v7, v41, v42
    v_max_u32 v7, v7, v43
    v_cmp_eq_u32 vcc, -1, v7
    s_cbranch_vccz Lok_10
    s_sub_u32 s13, s13, 1
    s_cbranch_scc0 Lsp_9
    s_mov_b32 s13, 0
Lok_10:
    v_mfma_f32_16x16x32_bf16 v[68:71], v[16:19], v[32:35], 0
    v_mfma_f32_16x16x32_bf16 v[68:71], v[16:19], v[36:39], v[68:71]
    v_mfma_f32_16x16x32_bf16 v[68:71], v[16:19], v[40:43], v[68:71]
    s_nop 7
    v_add_f32_dpp v68, v68, v68 row_ror:2 row_mask:0xf bank_mask:0xf
    v_add_f32_dpp v69, v69, v69 row_ror:2 row_mask:0xf bank_mask:0xf
    v_add_f32_dpp v70, v70, v70 row_ror:2 row_mask:0xf bank_mask:0xf
    v_add_f32_dpp v71, v71, v71 row_ror:2 row_mask:0xf bank_mask:0xf
    v_add_f32_dpp v68, v68, v68 row_ror:4 row_mask:0xf bank_mask:0xf
    v_add_f32_dpp v69, v69, v69 row_ror:4 row_mask:0xf bank_mask:0xf
    v_add_f32_dpp v70, v70, v70 row_ror:4 row_mask:0xf bank_mask:0xf
    v_add_f32_dpp v71, v71, v71 row_ror:4 row_mask:0xf bank_mask:0xf
    v_add_f32_dpp v68, v68, v68 row_ror:8 row_mask:0xf bank_mask:0xf
    v_add_f32_dpp v69, v69, v69 row_ror:8 row_mask:0xf bank_mask:0xf
    v_add_f32_dpp v70, v70, v70 row_ror:8 row_mask:0xf bank_mask:0xf
    v_add_f32_dpp v71, v71, v71 row_ror:8 row_mask:0xf bank_mask:0xf
    v_cvt_pk_bf16_f32 v14, v68, v69
    v_cvt_pk_bf16_f32 v15, v70, v71
    s_mov_b64 exec, 0x00030003
    buffer_store_dwordx2 v[14:15], v6, s[76:79], 0 offen
    s_cmp_eq_u32 s9, 0
    s_cbranch_scc0 L_A_done
    s_mov_b64 exec, 1
    v_mov_b32 v9, s44
    v_mov_b32 v10, 0
    buffer_store_dword v9, v10, s[72:75], 0 offen offset:0 sc1
L_A_done:
    s_endpgm
L_B:
    s_and_b32 s5, s5, 15
    s_lshl_b32 s9, s4, 4
    s_add_u32 s9, s9, s5
    s_lshr_b32 s6, s9, 5
    s_and_b32 s7, s9, 31
    v_mov_b32 v26, -1
    v_mov_b32 v27, -1
    v_mov_b32 v28, -1
    v_mov_b32 v29, -1
    s_mul_i32 s51, s4, 11
    s_add_u32 s51, s51, s5
    s_cmp_lt_u32 s5, 11
    s_cselect_b32 s51, s51, 127
    s_lshl_b32 s10, s51, 12
    s_lshl_b32 s11, s3, 7
    s_add_u32 s10, s10, s11
    s_add_u32 s10, s10, 1572864
    v_and_b32 v31, 3, v2
    v_lshlrev_b32 v31, 10, v31
    v_lshrrev_b32 v12, 2, v2
    v_lshl_add_u32 v31, v12, 5, v31
    v_lshl_add_u32 v31, v3, 3, v31
    v_add_u32 v31, s10, v31
    v_and_b32 v12, 31, v1
    v_lshrrev_b32 v13, 5, v1
    s_cmp_ge_u32 s3, 4
    s_cbranch_scc1 L_B_pv
    s_lshl_b32 s8, s9, 17
    s_lshl_b32 s10, s3, 15
    s_add_u32 s8, s8, s10
    v_lshlrev_b32 v4, 2, v3
    v_xor_b32 v4, v4, v2
    v_lshlrev_b32 v4, 4, v4
    v_lshl_add_u32 v4, v3, 10, v4
    v_xor_b32 v5, 32, v4
    v_xor_b32 v6, 48, v4
    v_xor_b32 v7, 16, v4
    v_lshrrev_b32 v8, 2, v2
    v_lshlrev_b32 v8, 1, v8
    v_mov_b32 v9, 0x78
    v_lshrrev_b32 v8, v8, v9
    v_and_b32 v8, 3, v8
    v_and_b32 v9, 3, v2
    v_lshl_add_u32 v8, v9, 2, v8
    v_xor_b32 v8, v8, v13
    v_lshlrev_b32 v8, 4, v8
    v_lshl_add_u32 v8, v12, 8, v8
    v_add_u32 v8, s10, v8
    v_xor_b32 v48, 0, v8
    v_xor_b32 v49, 32, v8
    v_xor_b32 v50, 64, v8
    v_xor_b32 v51, 96, v8
    v_xor_b32 v52, 128, v8
    v_xor_b32 v53, 160, v8
    v_xor_b32 v54, 192, v8
    v_xor_b32 v55, 224, v8
    s_waitcnt lgkmcnt(0)
    s_load_dword s44, s[40:41], 0
    s_mov_b32 s76, s18
    s_mov_b32 s77, s19
    s_mov_b32 s78, 16777216
    s_mov_b32 s79, 0x20000
    s_mov_b32 s72, s40
    s_mov_b32 s73, s41
    s_mov_b32 s74, 16777216
    s_mov_b32 s75, 0x20000
    buffer_store_dwordx2 v[26:27], v31, s[72:75], 0 offen sc1
    s_add_u32 m0, s10, 0
    s_add_u32 s11, s8, 0
    buffer_load_dwordx4 v4, s[76:79], s11 offen lds
    s_add_u32 m0, s10, 1024
    s_add_u32 s11, s8, 4096
    buffer_load_dwordx4 v5, s[76:79], s11 offen lds
    v_xor_b32 v8, v2, v13
    v_lshlrev_b32 v8, 4, v8
    v_lshl_add_u32 v8, v12, 10, v8
    v_add_u32 v8, 131072, v8
    v_xor_b32 v56, 0, v8
    v_xor_b32 v57, 32, v8
    v_xor_b32 v58, 64, v8
    v_xor_b32 v59, 96, v8
    v_xor_b32 v60, 128, v8
    v_xor_b32 v61, 160, v8
    v_xor_b32 v62, 192, v8
    v_xor_b32 v63, 224, v8
    v_lshlrev_b32 v65, 4, v12
    v_add_u32 v65, 131072, v65
    s_lshl_b32 s12, s3, 2
    v_add_u32 v64, s12, v65
    v_mul_u32_u24 v66, 272, v12
    v_lshl_add_u32 v66, v13, 3, v66
    s_lshl_b32 s12, s3, 6
    s_add_u32 s12, s12, 132096
    v_add_u32 v66, s12, v66
    v_lshlrev_b32 v68, 5, v12
    v_add_u32 v68, 140800, v68
    v_lshl_add_u32 v67, v13, 2, v68
    s_lshl_b32 s12, s3, 3
    v_add_u32 v67, s12, v67
    s_lshl_b32 s12, s9, 9
    s_add_u32 s12, s12, 786432
    v_lshlrev_b32 v25, 4, v12
    v_add_u32 v25, s12, v25
    s_add_u32 m0, s10, 2048
    s_add_u32 s11, s8, 8192
    buffer_load_dwordx4 v6, s[76:79], s11 offen lds
    s_add_u32 m0, s10, 3072
    s_add_u32 s11, s8, 12288
    buffer_load_dwordx4 v7, s[76:79], s11 offen lds
    v_lshrrev_b32 v69, 1, v1
    v_mul_u32_u24 v69, 2752, v69
    v_and_b32 v70, 1, v1
    v_lshl_add_u32 v69, v70, 4, v69
    s_lshl_b32 s56, s51, 1
    s_add_u32 s56, s56, s3
    s_and_b32 s56, s56, 7
    s_mul_i32 s56, s56, 176128
    s_lshl_b32 s57, s51, 5
    s_add_u32 s56, s56, s57
    s_add_u32 s57, s56, 88064
    s_mov_b32 s80, s30
    s_mov_b32 s81, s31
    s_mov_b32 s82, 1409024
    s_mov_b32 s83, 0x20000
    s_mov_b32 s20, s32
    s_mov_b32 s21, s33
    s_mov_b32 s22, 1409024
    s_mov_b32 s23, 0x20000
    s_add_u32 m0, s10, 4096
    s_add_u32 s11, s8, 16384
    buffer_load_dwordx4 v4, s[76:79], s11 offen lds
    s_add_u32 m0, s10, 5120
    s_add_u32 s11, s8, 20480
    buffer_load_dwordx4 v5, s[76:79], s11 offen lds
    s_add_u32 m0, s10, 6144
    s_add_u32 s11, s8, 24576
    buffer_load_dwordx4 v6, s[76:79], s11 offen lds
    s_add_u32 m0, s10, 7168
    s_add_u32 s11, s8, 28672
    buffer_load_dwordx4 v7, s[76:79], s11 offen lds
    s_waitcnt vmcnt(7)
    s_add_u32 m0, s10, 8192
    s_add_u32 s11, s8, 256
    buffer_load_dwordx4 v4, s[76:79], s11 offen lds
    s_waitcnt vmcnt(7)
    s_add_u32 m0, s10, 9216
    s_add_u32 s11, s8, 4352
    buffer_load_dwordx4 v5, s[76:79], s11 offen lds
    s_waitcnt lgkmcnt(0)
    s_add_u32 s44, s44, 1
    s_mul_i32 s48, s44, 0x9E3779B1
    s_xor_b32 s48, s48, 0x85EBCA6B
    s_mul_i32 s49, s44, 0xC2B2AE35
    s_add_u32 s49, s49, 0x27D4EB2F
    v_mov_b32 v28, s48
    v_mov_b32 v29, s49
    s_waitcnt vmcnt(7)
    s_add_u32 m0, s10, 10240
    s_add_u32 s11, s8, 8448
    buffer_load_dwordx4 v6, s[76:79], s11 offen lds
    s_waitcnt vmcnt(7)
    s_add_u32 m0, s10, 11264
    s_add_u32 s11, s8, 12544
    buffer_load_dwordx4 v7, s[76:79], s11 offen lds
    s_waitcnt vmcnt(7)
    s_add_u32 m0, s10, 12288
    s_add_u32 s11, s8, 16640
    buffer_load_dwordx4 v4, s[76:79], s11 offen lds
    s_waitcnt vmcnt(7)
    s_add_u32 m0, s10, 13312
    s_add_u32 s11, s8, 20736
    buffer_load_dwordx4 v5, s[76:79], s11 offen lds
    s_waitcnt vmcnt(7)
    s_add_u32 m0, s10, 14336
    s_add_u32 s11, s8, 24832
    buffer_load_dwordx4 v6, s[76:79], s11 offen lds
    s_waitcnt vmcnt(7)
    s_add_u32 m0, s10, 15360
    s_add_u32 s11, s8, 28928
    buffer_load_dwordx4 v7, s[76:79], s11 offen lds
    s_waitcnt vmcnt(7)
    s_add_u32 m0, s10, 16384
    s_add_u32 s11, s8, 512
    buffer_load_dwordx4 v4, s[76:79], s11 offen lds
    ds_read_b128 v[128:131], v48 offset:0
    ds_read_b128 v[132:135], v49 offset:0
    ds_read_b128 v[136:139], v50 offset:0
    ds_read_b128 v[140:143], v51 offset:0
    ds_read_b128 v[144:147], v52 offset:0
    ds_read_b128 v[148:151], v53 offset:0
    ds_read_b128 v[152:155], v54 offset:0
    ds_read_b128 v[156:159], v55 offset:0
    s_waitcnt vmcnt(7)
    s_add_u32 m0, s10, 17408
    s_add_u32 s11, s8, 4608
    buffer_load_dwordx4 v5, s[76:79], s11 offen lds
    s_waitcnt vmcnt(7)
    s_add_u32 m0, s10, 18432
    s_add_u32 s11, s8, 8704
    buffer_load_dwordx4 v6, s[76:79], s11 offen lds
    s_waitcnt vmcnt(7)
    s_add_u32 m0, s10, 19456
    s_add_u32 s11, s8, 12800
    buffer_load_dwordx4 v7, s[76:79], s11 offen lds
    s_waitcnt vmcnt(7)
    s_add_u32 m0, s10, 20480
    s_add_u32 s11, s8, 16896
    buffer_load_dwordx4 v4, s[76:79], s11 offen lds
    s_waitcnt vmcnt(7)
    s_add_u32 m0, s10, 21504
    s_add_u32 s11, s8, 20992
    buffer_load_dwordx4 v5, s[76:79], s11 offen lds
    s_waitcnt vmcnt(7)
    s_add_u32 m0, s10, 22528
    s_add_u32 s11, s8, 25088
    buffer_load_dwordx4 v6, s[76:79], s11 offen lds
    s_waitcnt vmcnt(7)
    s_add_u32 m0, s10, 23552
    s_add_u32 s11, s8, 29184
    buffer_load_dwordx4 v7, s[76:79], s11 offen lds
    s_waitcnt vmcnt(7)
    s_add_u32 m0, s10, 24576
    s_add_u32 s11, s8, 768
    buffer_load_dwordx4 v4, s[76:79], s11 offen lds
    ds_read_b128 v[160:163], v48 offset:8192
    ds_read_b128 v[164:167], v49 offset:8192
    ds_read_b128 v[168:171], v50 offset:8192
    ds_read_b128 v[172:175], v51 offset:8192
    ds_read_b128 v[176:179], v52 offset:8192
    ds_read_b128 v[180:183], v53 offset:8192
    ds_read_b128 v[184:187], v54 offset:8192
    ds_read_b128 v[188:191], v55 offset:8192
    s_waitcnt vmcnt(7)
    s_add_u32 m0, s10, 25600
    s_add_u32 s11, s8, 4864
    buffer_load_dwordx4 v5, s[76:79], s11 offen lds
    s_waitcnt vmcnt(7)
    s_add_u32 m0, s10, 26624
    s_add_u32 s11, s8, 8960
    buffer_load_dwordx4 v6, s[76:79], s11 offen lds
    s_waitcnt vmcnt(7)
    s_add_u32 m0, s10, 27648
    s_add_u32 s11, s8, 13056
    buffer_load_dwordx4 v7, s[76:79], s11 offen lds
    s_waitcnt vmcnt(7)
    s_add_u32 m0, s10, 28672
    s_add_u32 s11, s8, 17152
    buffer_load_dwordx4 v4, s[76:79], s11 offen lds
    s_waitcnt vmcnt(7)
    s_add_u32 m0, s10, 29696
    s_add_u32 s11, s8, 21248
    buffer_load_dwordx4 v5, s[76:79], s11 offen lds
    s_waitcnt vmcnt(7)
    s_add_u32 m0, s10, 30720
    s_add_u32 s11, s8, 25344
    buffer_load_dwordx4 v6, s[76:79], s11 offen lds
    s_waitcnt vmcnt(7)
    s_add_u32 m0, s10, 31744
    s_add_u32 s11, s8, 29440
    buffer_load_dwordx4 v7, s[76:79], s11 offen lds
    s_cmp_eq_u32 s3, 3
    s_cbranch_scc0 L_B_nogo
    s_lshl_b32 s12, s9, 7
    s_add_u32 s12, s12, 32768
    v_mov_b32 v24, s12
    s_mov_b64 exec, 1
    buffer_store_dwordx4 v[26:29], v24, s[72:75], 0 offen sc1
    s_mov_b64 exec, -1
L_B_nogo:
    s_waitcnt vmcnt(4)
    s_barrier
    s_waitcnt vmcnt(8)
    ds_read_b128 v[192:195], v48 offset:16384
    ds_read_b128 v[196:199], v49 offset:16384
    ds_read_b128 v[200:203], v50 offset:16384
    ds_read_b128 v[204:207], v51 offset:16384
    ds_read_b128 v[208:211], v52 offset:16384
    ds_read_b128 v[212:215], v53 offset:16384
    ds_read_b128 v[216:219], v54 offset:16384
    ds_read_b128 v[220:223], v55 offset:16384
    s_waitcnt lgkmcnt(0)
    s_barrier
    ds_read_b128 v[96:99], v56 offset:0
    ds_read_b128 v[100:103], v57 offset:0
    ds_read_b128 v[104:107], v58 offset:0
    ds_read_b128 v[108:111], v59 offset:0
    ds_read_b128 v[112:115], v60 offset:0
    ds_read_b128 v[116:119], v61 offset:0
    s_waitcnt vmcnt(0)
    ds_read_b128 v[224:227], v48 offset:24576
    ds_read_b128 v[228:231], v49 offset:24576
    ds_read_b128 v[232:235], v50 offset:24576
    ds_read_b128 v[236:239], v51 offset:24576
    ds_read_b128 v[240:243], v52 offset:24576
    ds_read_b128 v[244:247], v53 offset:24576
    ds_read_b128 v[248:251], v54 offset:24576
    ds_read_b128 v[252:255], v55 offset:24576
    s_cmp_ge_u32 s51, 86
    s_cbranch_scc1 L_B_nofe
    buffer_load_dwordx4 v[72:75], v69, s[80:83], s56 offen
    buffer_load_dwordx4 v[76:79], v69, s[80:83], s57 offen
    buffer_load_dwordx4 v[80:83], v69, s[20:23], s56 offen
L_B_nofe:
    s_waitcnt lgkmcnt(13)
    v_mfma_f32_32x32x16_bf16 v[32:47], v[128:131], v[96:99], 0
    ds_read_b128 v[120:123], v62 offset:0
    s_waitcnt lgkmcnt(13)
    v_mfma_f32_32x32x16_bf16 v[32:47], v[132:135], v[100:103], v[32:47]
    ds_read_b128 v[124:127], v63 offset:0
    s_waitcnt lgkmcnt(13)
    v_mfma_f32_32x32x16_bf16 v[32:47], v[136:139], v[104:107], v[32:47]
    ds_read_b128 v[96:99], v56 offset:256
    s_waitcnt lgkmcnt(13)
    v_mfma_f32_32x32x16_bf16 v[32:47], v[140:143], v[108:111], v[32:47]
    ds_read_b128 v[100:103], v57 offset:256
    s_waitcnt lgkmcnt(13)
    v_mfma_f32_32x32x16_bf16 v[32:47], v[144:147], v[112:115], v[32:47]
    ds_read_b128 v[104:107], v58 offset:256
    s_waitcnt lgkmcnt(13)
    v_mfma_f32_32x32x16_bf16 v[32:47], v[148:151], v[116:119], v[32:47]
    ds_read_b128 v[108:111], v59 offset:256
    s_waitcnt lgkmcnt(5)
    v_mfma_f32_32x32x16_bf16 v[32:47], v[152:155], v[120:123], v[32:47]
    ds_read_b128 v[112:115], v60 offset:256
    s_waitcnt lgkmcnt(5)
    v_mfma_f32_32x32x16_bf16 v[32:47], v[156:159], v[124:127], v[32:47]
    ds_read_b128 v[116:119], v61 offset:256
    s_waitcnt lgkmcnt(5)
    v_mfma_f32_32x32x16_bf16 v[32:47], v[160:163], v[96:99], v[32:47]
    ds_read_b128 v[120:123], v62 offset:256
    s_waitcnt lgkmcnt(5)
    v_mfma_f32_32x32x16_bf16 v[32:47], v[164:167], v[100:103], v[32:47]
    ds_read_b128 v[124:127], v63 offset:256
    s_waitcnt lgkmcnt(5)
    v_mfma_f32_32x32x16_bf16 v[32:47], v[168:171], v[104:107], v[32:47]
    ds_read_b128 v[96:99], v56 offset:512
    s_waitcnt lgkmcnt(5)
    v_mfma_f32_32x32x16_bf16 v[32:47], v[172:175], v[108:111], v[32:47]
    ds_read_b128 v[100:103], v57 offset:512
    s_waitcnt lgkmcnt(5)
    v_mfma_f32_32x32x16_bf16 v[32:47], v[176:179], v[112:115], v[32:47]
    ds_read_b128 v[104:107], v58 offset:512
    s_waitcnt lgkmcnt(5)
    v_mfma_f32_32x32x16_bf16 v[32:47], v[180:183], v[116:119], v[32:47]
    ds_read_b128 v[108:111], v59 offset:512
    s_waitcnt lgkmcnt(5)
    v_mfma_f32_32x32x16_bf16 v[32:47], v[184:187], v[120:123], v[32:47]
    ds_read_b128 v[112:115], v60 offset:512
    s_waitcnt lgkmcnt(5)
    v_mfma_f32_32x32x16_bf16 v[32:47], v[188:191], v[124:127], v[32:47]
    ds_read_b128 v[116:119], v61 offset:512
    s_waitcnt lgkmcnt(5)
    v_mfma_f32_32x32x16_bf16 v[32:47], v[192:195], v[96:99], v[32:47]
    ds_read_b128 v[120:123], v62 offset:512
    s_waitcnt lgkmcnt(5)
    v_mfma_f32_32x32x16_bf16 v[32:47], v[196:199], v[100:103], v[32:47]
    ds_read_b128 v[124:127], v63 offset:512
    s_waitcnt lgkmcnt(5)
    v_mfma_f32_32x32x16_bf16 v[32:47], v[200:203], v[104:107], v[32:47]
    ds_read_b128 v[96:99], v56 offset:768
    s_waitcnt lgkmcnt(5)
    v_mfma_f32_32x32x16_bf16 v[32:47], v[204:207], v[108:111], v[32:47]
    ds_read_b128 v[100:103], v57 offset:768
    s_waitcnt lgkmcnt(5)
    v_mfma_f32_32x32x16_bf16 v[32:47], v[208:211], v[112:115], v[32:47]
    ds_read_b128 v[104:107], v58 offset:768
    s_waitcnt lgkmcnt(5)
    v_mfma_f32_32x32x16_bf16 v[32:47], v[212:215], v[116:119], v[32:47]
    ds_read_b128 v[108:111], v59 offset:768
    s_waitcnt lgkmcnt(5)
    v_mfma_f32_32x32x16_bf16 v[32:47], v[216:219], v[120:123], v[32:47]
    ds_read_b128 v[112:115], v60 offset:768
    s_waitcnt lgkmcnt(5)
    v_mfma_f32_32x32x16_bf16 v[32:47], v[220:223], v[124:127], v[32:47]
    ds_read_b128 v[116:119], v61 offset:768
    s_waitcnt lgkmcnt(5)
    v_mfma_f32_32x32x16_bf16 v[32:47], v[224:227], v[96:99], v[32:47]
    ds_read_b128 v[120:123], v62 offset:768
    s_waitcnt lgkmcnt(5)
    v_mfma_f32_32x32x16_bf16 v[32:47], v[228:231], v[100:103], v[32:47]
    ds_read_b128 v[124:127], v63 offset:768
    s_waitcnt lgkmcnt(5)
    v_mfma_f32_32x32x16_bf16 v[32:47], v[232:235], v[104:107], v[32:47]
    s_waitcnt lgkmcnt(4)
    v_mfma_f32_32x32x16_bf16 v[32:47], v[236:239], v[108:111], v[32:47]
    s_waitcnt lgkmcnt(3)
    v_mfma_f32_32x32x16_bf16 v[32:47], v[240:243], v[112:115], v[32:47]
    s_waitcnt lgkmcnt(2)
    v_mfma_f32_32x32x16_bf16 v[32:47], v[244:247], v[116:119], v[32:47]
    s_waitcnt lgkmcnt(1)
    v_mfma_f32_32x32x16_bf16 v[32:47], v[248:251], v[120:123], v[32:47]
    s_waitcnt lgkmcnt(0)
    v_mfma_f32_32x32x16_bf16 v[32:47], v[252:255], v[124:127], v[32:47]
    s_barrier
    s_nop 10
    v_max3_f32 v22, v32, v33, v34
    v_max3_f32 v23, v35, v36, v37
    v_max3_f32 v22, v22, v38, v39
    v_max3_f32 v23, v23, v40, v41
    v_max3_f32 v22, v22, v42, v43
    v_max3_f32 v23, v23, v44, v45
    v_max3_f32 v22, v22, v46, v47
    v_max_f32 v22, v22, v23
    v_mov_b32 v23, v22
    s_nop 1
    v_permlane32_swap_b32 v22, v23
    v_max_f32 v22, v22, v23
    ds_write_b32 v64, v22
    s_waitcnt lgkmcnt(0)
    s_barrier
    ds_read_b128 v[96:99], v65
    s_waitcnt lgkmcnt(0)
    v_max3_f32 v26, v96, v97, v98
    v_max_f32 v26, v26, v99
    v_sub_f32 v32, v32, v26
    v_sub_f32 v33, v33, v26
    v_sub_f32 v34, v34, v26
    v_sub_f32 v35, v35, v26
    v_exp_f32 v32, v32
    v_exp_f32 v33, v33
    v_exp_f32 v34, v34
    v_exp_f32 v35, v35
    v_cvt_pk_bf16_f32 v8, v32, v33
    v_cvt_pk_bf16_f32 v9, v34, v35
    ds_write_b64 v66, v[8:9] offset:0
    v_sub_f32 v36, v36, v26
    v_sub_f32 v37, v37, v26
    v_sub_f32 v38, v38, v26
    v_sub_f32 v39, v39, v26
    v_exp_f32 v36, v36
    v_exp_f32 v37, v37
    v_exp_f32 v38, v38
    v_exp_f32 v39, v39
    v_cvt_pk_bf16_f32 v10, v36, v37
    v_cvt_pk_bf16_f32 v11, v38, v39
    ds_write_b64 v66, v[10:11] offset:16
    v_sub_f32 v40, v40, v26
    v_sub_f32 v41, v41, v26
    v_sub_f32 v42, v42, v26
    v_sub_f32 v43, v43, v26
    v_exp_f32 v40, v40
    v_exp_f32 v41, v41
    v_exp_f32 v42, v42
    v_exp_f32 v43, v43
    v_cvt_pk_bf16_f32 v8, v40, v41
    v_cvt_pk_bf16_f32 v9, v42, v43
    ds_write_b64 v66, v[8:9] offset:32
    v_sub_f32 v44, v44, v26
    v_sub_f32 v45, v45, v26
    v_sub_f32 v46, v46, v26
    v_sub_f32 v47, v47, v26
    v_exp_f32 v44, v44
    v_exp_f32 v45, v45
    v_exp_f32 v46, v46
    v_exp_f32 v47, v47
    v_cvt_pk_bf16_f32 v10, v44, v45
    v_cvt_pk_bf16_f32 v11, v46, v47
    ds_write_b64 v66, v[10:11] offset:48
    s_waitcnt lgkmcnt(0)
    s_barrier
    v_add_f32 v32, v32, v40
    v_add_f32 v33, v33, v41
    v_add_f32 v34, v34, v42
    v_add_f32 v35, v35, v43
    v_add_f32 v36, v36, v44
    v_add_f32 v37, v37, v45
    v_add_f32 v38, v38, v46
    v_add_f32 v39, v39, v47
    v_add_f32 v32, v32, v36
    v_add_f32 v33, v33, v37
    v_add_f32 v34, v34, v38
    v_add_f32 v35, v35, v39
    v_add_f32 v32, v32, v34
    v_add_f32 v33, v33, v35
    v_add_f32 v32, v32, v33
    ds_write_b32 v67, v32
    s_waitcnt lgkmcnt(0)
    s_barrier
    ds_read_b128 v[32:35], v68
    ds_read_b128 v[36:39], v68 offset:16
    s_waitcnt lgkmcnt(0)
    v_add_f32 v32, v32, v36
    v_add_f32 v33, v33, v37
    v_add_f32 v34, v34, v38
    v_add_f32 v35, v35, v39
    v_add_f32 v32, v32, v34
    v_add_f32 v33, v33, v35
    v_add_f32 v27, v32, v33
    s_barrier
    s_cmp_eq_u32 s3, 0
    s_cbranch_scc0 L_B_nost
    s_mov_b32 exec_hi, 0
    buffer_store_dwordx4 v[26:29], v25, s[72:75], 0 offen sc1
    s_mov_b64 exec, -1
L_B_nost:
    s_nop 2
    s_branch L_B_post
L_B_pv:
    s_sub_u32 s12, s3, 4
    s_lshl_b32 s11, s6, 16
    s_lshl_b32 s10, s12, 10
    s_add_u32 s11, s11, s10
    s_add_u32 s11, s11, 524288
    v_lshlrev_b32 v7, 4, v1
    v_add_u32 v7, s11, v7
    v_add_u32 v6, 4096, v7
    s_waitcnt lgkmcnt(0)
    s_load_dword s44, s[40:41], 0
    s_mov_b32 s72, s40
    s_mov_b32 s73, s41
    s_mov_b32 s74, 16777216
    s_mov_b32 s75, 0x20000
    buffer_store_dwordx2 v[26:27], v31, s[72:75], 0 offen sc1
    s_lshr_b32 s10, s12, 1
    s_and_b32 s11, s12, 1
    s_lshl_b32 s11, s11, 5
    s_xor_b32 s11, s11, s10
    v_lshrrev_b32 v8, 1, v1
    v_xor_b32 v8, s11, v8
    v_lshlrev_b32 v8, 4, v8
    v_and_b32 v9, 1, v1
    v_lshl_add_u32 v8, v9, 3, v8
    s_lshl_b32 s10, s10, 10
    s_add_u32 s10, s10, 131072
    v_add_u32 v8, s10, v8
    v_xor_b32 v64, 0, v8
    v_xor_b32 v65, 32, v8
    v_xor_b32 v66, 64, v8
    v_xor_b32 v67, 96, v8
    v_xor_b32 v68, 128, v8
    v_xor_b32 v69, 160, v8
    v_xor_b32 v70, 192, v8
    v_xor_b32 v71, 224, v8
    v_lshrrev_b32 v22, 2, v2
    v_lshl_add_u32 v23, v13, 3, v22
    v_lshlrev_b32 v23, 8, v23
    v_lshl_add_u32 v23, v9, 3, v23
    v_and_b32 v24, 1, v3
    v_bfe_u32 v10, v1, 1, 1
    v_lshl_add_u32 v24, v24, 1, v10
    v_lshlrev_b32 v22, 2, v22
    v_xor_b32 v24, v24, v22
    v_mul_u32_u24 v22, 3, v13
    v_xor_b32 v24, v24, v22
    v_lshl_add_u32 v23, v24, 4, v23
    s_lshl_b32 s10, s12, 13
    v_add_u32 v23, s10, v23
    v_xor_b32 v24, 32, v23
    v_add_u32 v24, 1024, v24
    v_xor_b32 v72, 0, v23
    v_add_u32 v80, 0x10000, v72
    v_xor_b32 v73, 0, v24
    v_add_u32 v81, 0x10000, v73
    v_xor_b32 v74, 64, v23
    v_add_u32 v82, 0x10000, v74
    v_xor_b32 v75, 64, v24
    v_add_u32 v83, 0x10000, v75
    v_xor_b32 v76, 128, v23
    v_add_u32 v84, 0x10000, v76
    v_xor_b32 v77, 128, v24
    v_add_u32 v85, 0x10000, v77
    v_xor_b32 v78, 192, v23
    v_add_u32 v86, 0x10000, v78
    v_xor_b32 v79, 192, v24
    v_add_u32 v87, 0x10000, v79
    v_mul_u32_u24 v88, 272, v12
    v_lshl_add_u32 v88, v13, 4, v88
    v_add_u32 v88, 132096, v88
    s_lshl_b32 s10, s12, 14
    v_mul_u32_u24 v89, 144, v12
    v_lshl_add_u32 v89, v13, 3, v89
    v_add_u32 v89, s10, v89
    v_lshrrev_b32 v22, 3, v1
    v_and_b32 v23, 7, v1
    v_mul_u32_u24 v90, 144, v22
    v_lshl_add_u32 v90, v23, 4, v90
    v_add_u32 v90, s10, v90
    s_lshl_b32 s10, s12, 15
    s_lshl_b32 s11, s9, 8
    s_add_u32 s10, s10, s11
    s_add_u32 s10, s10, 2097152
    v_lshlrev_b32 v30, 17, v22
    v_lshl_add_u32 v30, v23, 4, v30
    v_add_u32 v30, s10, v30
    s_mov_b32 s53, 1048576
    s_mov_b32 s54, 2097152
    s_mov_b32 s55, 3145728
    s_lshl_b32 s10, s12, 14
    s_lshl_b32 s11, s9, 7
    s_add_u32 s10, s10, s11
    s_add_u32 s10, s10, 917504
    v_mov_b32 v25, s10
    s_waitcnt lgkmcnt(0)
    s_add_u32 s44, s44, 1
    s_mul_i32 s48, s44, 0x9E3779B1
    s_xor_b32 s48, s48, 0x85EBCA6B
    s_mul_i32 s49, s44, 0xC2B2AE35
    s_add_u32 s49, s49, 0x27D4EB2F
    v_mov_b32 v28, s48
    v_mov_b32 v29, s49
    s_barrier
    buffer_load_dwordx4 v[128:131], v7, s[72:75], 0 offen sc1
    buffer_load_dwordx4 v[132:135], v6, s[72:75], 0 offen sc1
    buffer_load_dwordx4 v[136:139], v7, s[72:75], s65 offen sc1
    buffer_load_dwordx4 v[140:143], v6, s[72:75], s65 offen sc1
    buffer_load_dwordx4 v[144:147], v7, s[72:75], s66 offen sc1
    buffer_load_dwordx4 v[148:151], v6, s[72:75], s66 offen sc1
    buffer_load_dwordx4 v[152:155], v7, s[72:75], s67 offen sc1
    buffer_load_dwordx4 v[156:159], v6, s[72:75], s67 offen sc1
    buffer_load_dwordx4 v[160:163], v7, s[72:75], s68 offen sc1
    buffer_load_dwordx4 v[164:167], v6, s[72:75], s68 offen sc1
    buffer_load_dwordx4 v[168:171], v7, s[72:75], s69 offen sc1
    buffer_load_dwordx4 v[172:175], v6, s[72:75], s69 offen sc1
    buffer_load_dwordx4 v[176:179], v7, s[72:75], s70 offen sc1
    buffer_load_dwordx4 v[180:183], v6, s[72:75], s70 offen sc1
    buffer_load_dwordx4 v[184:187], v7, s[72:75], s71 offen sc1
    buffer_load_dwordx4 v[188:191], v6, s[72:75], s71 offen sc1
    s_mov_b32 s60, 0
    s_waitcnt vmcnt(15)
    v_cmp_ne_u64 vcc, s[48:49], v[130:131]
    ds_write_b64 v64, v[128:129] offset:0
    s_cmp_lg_u64 vcc, 0
    s_addc_u32 s60, s60, s60
    s_waitcnt vmcnt(14)
    v_cmp_ne_u64 vcc, s[48:49], v[134:135]
    ds_write_b64 v65, v[132:133] offset:2048
    s_cmp_lg_u64 vcc, 0
    s_addc_u32 s60, s60, s60
    s_waitcnt vmcnt(13)
    v_cmp_ne_u64 vcc, s[48:49], v[138:139]
    ds_write_b64 v66, v[136:137] offset:4096
    s_cmp_lg_u64 vcc, 0
    s_addc_u32 s60, s60, s60
    s_waitcnt vmcnt(12)
    v_cmp_ne_u64 vcc, s[48:49], v[142:143]
    ds_write_b64 v67, v[140:141] offset:6144
    s_cmp_lg_u64 vcc, 0
    s_addc_u32 s60, s60, s60
    s_waitcnt vmcnt(11)
    v_cmp_ne_u64 vcc, s[48:49], v[146:147]
    ds_write_b64 v68, v[144:145] offset:8192
    s_cmp_lg_u64 vcc, 0
    s_addc_u32 s60, s60, s60
    s_waitcnt vmcnt(10)
    v_cmp_ne_u64 vcc, s[48:49], v[150:151]
    ds_write_b64 v69, v[148:149] offset:10240
    s_cmp_lg_u64 vcc, 0
    s_addc_u32 s60, s60, s60
    s_waitcnt vmcnt(9)
    v_cmp_ne_u64 vcc, s[48:49], v[154:155]
    ds_write_b64 v70, v[152:153] offset:12288
    s_cmp_lg_u64 vcc, 0
    s_addc_u32 s60, s60, s60
    s_waitcnt vmcnt(8)
    v_cmp_ne_u64 vcc, s[48:49], v[158:159]
    ds_write_b64 v71, v[156:157] offset:14336
    s_cmp_lg_u64 vcc, 0
    s_addc_u32 s60, s60, s60
    s_waitcnt vmcnt(7)
    v_cmp_ne_u64 vcc, s[48:49], v[162:163]
    ds_write_b64 v64, v[160:161] offset:16384
    s_cmp_lg_u64 vcc, 0
    s_addc_u32 s60, s60, s60
    s_waitcnt vmcnt(6)
    v_cmp_ne_u64 vcc, s[48:49], v[166:167]
    ds_write_b64 v65, v[164:165] offset:18432
    s_cmp_lg_u64 vcc, 0
    s_addc_u32 s60, s60, s60
    s_waitcnt vmcnt(5)
    v_cmp_ne_u64 vcc, s[48:49], v[170:171]
    ds_write_b64 v66, v[168:169] offset:20480
    s_cmp_lg_u64 vcc, 0
    s_addc_u32 s60, s60, s60
    s_waitcnt vmcnt(4)
    v_cmp_ne_u64 vcc, s[48:49], v[174:175]
    ds_write_b64 v67, v[172:173] offset:22528
    s_cmp_lg_u64 vcc, 0
    s_addc_u32 s60, s60, s60
    s_waitcnt vmcnt(3)
    v_cmp_ne_u64 vcc, s[48:49], v[178:179]
    ds_write_b64 v68, v[176:177] offset:24576
    s_cmp_lg_u64 vcc, 0
    s_addc_u32 s60, s60, s60
    s_waitcnt vmcnt(2)
    v_cmp_ne_u64 vcc, s[48:49], v[182:183]
    ds_write_b64 v69, v[180:181] offset:26624
    s_cmp_lg_u64 vcc, 0
    s_addc_u32 s60, s60, s60
    s_waitcnt vmcnt(1)
    v_cmp_ne_u64 vcc, s[48:49], v[186:187]
    ds_write_b64 v70, v[184:185] offset:28672
    s_cmp_lg_u64 vcc, 0
    s_addc_u32 s60, s60, s60
    s_waitcnt vmcnt(0)
    v_cmp_ne_u64 vcc, s[48:49], v[190:191]
    ds_write_b64 v71, v[188:189] offset:30720
    s_cmp_lg_u64 vcc, 0
    s_addc_u32 s60, s60, s60
    s_cmp_eq_u32 s60, 0
    s_cbranch_scc1 L_B_gotq
L_B_qretry:
    s_mov_b32 s61, s60
    s_ff1_i32_b32 s20, s61
    s_bitset0_b32 s61, s20
    s_sub_u32 s10, 15, s20
    s_lshl_b32 s11, s10, 12
    buffer_load_dwordx4 v[128:131], v7, s[72:75], s11 offen sc1
    s_and_b32 s11, s10, 7
    s_lshl_b32 s11, s11, 5
    s_lshl_b32 s10, s10, 11
    v_xor_b32 v192, s11, v64
    v_add_u32 v192, s10, v192
    s_cmp_eq_u32 s61, 0
    s_cbranch_scc1 L_B_qs_issued1
    s_ff1_i32_b32 s21, s61
    s_bitset0_b32 s61, s21
    s_sub_u32 s10, 15, s21
    s_lshl_b32 s11, s10, 12
    buffer_load_dwordx4 v[132:135], v7, s[72:75], s11 offen sc1
    s_and_b32 s11, s10, 7
    s_lshl_b32 s11, s11, 5
    s_lshl_b32 s10, s10, 11
    v_xor_b32 v193, s11, v64
    v_add_u32 v193, s10, v193
    s_cmp_eq_u32 s61, 0
    s_cbranch_scc1 L_B_qs_issued2
    s_ff1_i32_b32 s22, s61
    s_bitset0_b32 s61, s22
    s_sub_u32 s10, 15, s22
    s_lshl_b32 s11, s10, 12
    buffer_load_dwordx4 v[136:139], v7, s[72:75], s11 offen sc1
    s_and_b32 s11, s10, 7
    s_lshl_b32 s11, s11, 5
    s_lshl_b32 s10, s10, 11
    v_xor_b32 v194, s11, v64
    v_add_u32 v194, s10, v194
    s_cmp_eq_u32 s61, 0
    s_cbranch_scc1 L_B_qs_issued3
    s_ff1_i32_b32 s23, s61
    s_bitset0_b32 s61, s23
    s_sub_u32 s10, 15, s23
    s_lshl_b32 s11, s10, 12
    buffer_load_dwordx4 v[140:143], v7, s[72:75], s11 offen sc1
    s_and_b32 s11, s10, 7
    s_lshl_b32 s11, s11, 5
    s_lshl_b32 s10, s10, 11
    v_xor_b32 v195, s11, v64
    v_add_u32 v195, s10, v195
    s_cmp_eq_u32 s61, 0
    s_cbranch_scc1 L_B_qs_issued4
    s_ff1_i32_b32 s24, s61
    s_bitset0_b32 s61, s24
    s_sub_u32 s10, 15, s24
    s_lshl_b32 s11, s10, 12
    buffer_load_dwordx4 v[144:147], v7, s[72:75], s11 offen sc1
    s_and_b32 s11, s10, 7
    s_lshl_b32 s11, s11, 5
    s_lshl_b32 s10, s10, 11
    v_xor_b32 v196, s11, v64
    v_add_u32 v196, s10, v196
    s_cmp_eq_u32 s61, 0
    s_cbranch_scc1 L_B_qs_issued5
    s_ff1_i32_b32 s25, s61
    s_bitset0_b32 s61, s25
    s_sub_u32 s10, 15, s25
    s_lshl_b32 s11, s10, 12
    buffer_load_dwordx4 v[148:151], v7, s[72:75], s11 offen sc1
    s_and_b32 s11, s10, 7
    s_lshl_b32 s11, s11, 5
    s_lshl_b32 s10, s10, 11
    v_xor_b32 v197, s11, v64
    v_add_u32 v197, s10, v197
    s_cmp_eq_u32 s61, 0
    s_cbranch_scc1 L_B_qs_issued6
    s_ff1_i32_b32 s26, s61
    s_bitset0_b32 s61, s26
    s_sub_u32 s10, 15, s26
    s_lshl_b32 s11, s10, 12
    buffer_load_dwordx4 v[152:155], v7, s[72:75], s11 offen sc1
    s_and_b32 s11, s10, 7
    s_lshl_b32 s11, s11, 5
    s_lshl_b32 s10, s10, 11
    v_xor_b32 v198, s11, v64
    v_add_u32 v198, s10, v198
    s_cmp_eq_u32 s61, 0
    s_cbranch_scc1 L_B_qs_issued7
    s_ff1_i32_b32 s27, s61
    s_bitset0_b32 s61, s27
    s_sub_u32 s10, 15, s27
    s_lshl_b32 s11, s10, 12
    buffer_load_dwordx4 v[156:159], v7, s[72:75], s11 offen sc1
    s_and_b32 s11, s10, 7
    s_lshl_b32 s11, s11, 5
    s_lshl_b32 s10, s10, 11
    v_xor_b32 v199, s11, v64
    v_add_u32 v199, s10, v199
L_B_qs_issued8:
    s_waitcnt vmcnt(0)
    v_cmp_ne_u64 vcc, s[48:49], v[158:159]
    s_cbranch_vccnz Lqs_11
    ds_write_b64 v199, v[156:157]
    s_bitset0_b32 s60, s27
Lqs_11:
L_B_qs_issued7:
    s_waitcnt vmcnt(0)
    v_cmp_ne_u64 vcc, s[48:49], v[154:155]
    s_cbranch_vccnz Lqs_12
    ds_write_b64 v198, v[152:153]
    s_bitset0_b32 s60, s26
Lqs_12:
L_B_qs_issued6:
    s_waitcnt vmcnt(0)
    v_cmp_ne_u64 vcc, s[48:49], v[150:151]
    s_cbranch_vccnz Lqs_13
    ds_write_b64 v197, v[148:149]
    s_bitset0_b32 s60, s25
Lqs_13:
L_B_qs_issued5:
    s_waitcnt vmcnt(0)
    v_cmp_ne_u64 vcc, s[48:49], v[146:147]
    s_cbranch_vccnz Lqs_14
    ds_write_b64 v196, v[144:145]
    s_bitset0_b32 s60, s24
Lqs_14:
L_B_qs_issued4:
    s_waitcnt vmcnt(0)
    v_cmp_ne_u64 vcc, s[48:49], v[142:143]
    s_cbranch_vccnz Lqs_15
    ds_write_b64 v195, v[140:141]
    s_bitset0_b32 s60, s23
Lqs_15:
L_B_qs_issued3:
    s_waitcnt vmcnt(0)
    v_cmp_ne_u64 vcc, s[48:49], v[138:139]
    s_cbranch_vccnz Lqs_16
    ds_write_b64 v194, v[136:137]
    s_bitset0_b32 s60, s22
Lqs_16:
L_B_qs_issued2:
    s_waitcnt vmcnt(0)
    v_cmp_ne_u64 vcc, s[48:49], v[134:135]
    s_cbranch_vccnz Lqs_17
    ds_write_b64 v193, v[132:133]
    s_bitset0_b32 s60, s21
Lqs_17:
L_B_qs_issued1:
    s_waitcnt vmcnt(0)
    v_cmp_ne_u64 vcc, s[48:49], v[130:131]
    s_cbranch_vccnz Lqs_18
    ds_write_b64 v192, v[128:129]
    s_bitset0_b32 s60, s20
Lqs_18:
    s_cmp_eq_u32 s60, 0
    s_cbranch_scc1 L_B_gotq
    s_sub_u32 s13, s13, 1
    s_cbranch_scc0 L_B_qretry
    s_mov_b32 s13, 0
L_B_gotq:
    s_waitcnt lgkmcnt(0)
    s_barrier
    s_cmp_lt_u32 s12, 3
    s_cbranch_scc1 L_B_trr
    s_barrier
L_B_trr:
    ds_read_b64_tr_b16 v[128:129], v72 offset:0
    ds_read_b64_tr_b16 v[130:131], v73 offset:0
    ds_read_b64_tr_b16 v[132:133], v72 offset:4096
    ds_read_b64_tr_b16 v[134:135], v73 offset:4096
    ds_read_b64_tr_b16 v[136:137], v72 offset:32768
    ds_read_b64_tr_b16 v[138:139], v73 offset:32768
    ds_read_b64_tr_b16 v[140:141], v72 offset:36864
    ds_read_b64_tr_b16 v[142:143], v73 offset:36864
    ds_read_b64_tr_b16 v[144:145], v80 offset:0
    ds_read_b64_tr_b16 v[146:147], v81 offset:0
    ds_read_b64_tr_b16 v[148:149], v80 offset:4096
    ds_read_b64_tr_b16 v[150:151], v81 offset:4096
    ds_read_b64_tr_b16 v[152:153], v80 offset:32768
    ds_read_b64_tr_b16 v[154:155], v81 offset:32768
    ds_read_b64_tr_b16 v[156:157], v80 offset:36864
    ds_read_b64_tr_b16 v[158:159], v81 offset:36864
    ds_read_b64_tr_b16 v[160:161], v74 offset:0
    ds_read_b64_tr_b16 v[162:163], v75 offset:0
    ds_read_b64_tr_b16 v[164:165], v74 offset:4096
    ds_read_b64_tr_b16 v[166:167], v75 offset:4096
    ds_read_b64_tr_b16 v[168:169], v74 offset:32768
    ds_read_b64_tr_b16 v[170:171], v75 offset:32768
    ds_read_b64_tr_b16 v[172:173], v74 offset:36864
    ds_read_b64_tr_b16 v[174:175], v75 offset:36864
    ds_read_b64_tr_b16 v[176:177], v82 offset:0
    ds_read_b64_tr_b16 v[178:179], v83 offset:0
    ds_read_b64_tr_b16 v[180:181], v82 offset:4096
    ds_read_b64_tr_b16 v[182:183], v83 offset:4096
    ds_read_b64_tr_b16 v[184:185], v82 offset:32768
    ds_read_b64_tr_b16 v[186:187], v83 offset:32768
    ds_read_b64_tr_b16 v[188:189], v82 offset:36864
    ds_read_b64_tr_b16 v[190:191], v83 offset:36864
    ds_read_b64_tr_b16 v[192:193], v76 offset:0
    ds_read_b64_tr_b16 v[194:195], v77 offset:0
    ds_read_b64_tr_b16 v[196:197], v76 offset:4096
    ds_read_b64_tr_b16 v[198:199], v77 offset:4096
    ds_read_b64_tr_b16 v[200:201], v76 offset:32768
    ds_read_b64_tr_b16 v[202:203], v77 offset:32768
    ds_read_b64_tr_b16 v[204:205], v76 offset:36864
    ds_read_b64_tr_b16 v[206:207], v77 offset:36864
    ds_read_b64_tr_b16 v[208:209], v84 offset:0
    ds_read_b64_tr_b16 v[210:211], v85 offset:0
    ds_read_b64_tr_b16 v[212:213], v84 offset:4096
    ds_read_b64_tr_b16 v[214:215], v85 offset:4096
    ds_read_b64_tr_b16 v[216:217], v84 offset:32768
    ds_read_b64_tr_b16 v[218:219], v85 offset:32768
    ds_read_b64_tr_b16 v[220:221], v84 offset:36864
    ds_read_b64_tr_b16 v[222:223], v85 offset:36864
    ds_read_b64_tr_b16 v[224:225], v78 offset:0
    ds_read_b64_tr_b16 v[226:227], v79 offset:0
    ds_read_b64_tr_b16 v[228:229], v78 offset:4096
    ds_read_b64_tr_b16 v[230:231], v79 offset:4096
    ds_read_b64_tr_b16 v[232:233], v78 offset:32768
    ds_read_b64_tr_b16 v[234:235], v79 offset:32768
    ds_read_b64_tr_b16 v[236:237], v78 offset:36864
    ds_read_b64_tr_b16 v[238:239], v79 offset:36864
    ds_read_b64_tr_b16 v[240:241], v86 offset:0
    ds_read_b64_tr_b16 v[242:243], v87 offset:0
    ds_read_b64_tr_b16 v[244:245], v86 offset:4096
    ds_read_b64_tr_b16 v[246:247], v87 offset:4096
    ds_read_b64_tr_b16 v[248:249], v86 offset:32768
    ds_read_b64_tr_b16 v[250:251], v87 offset:32768
    ds_read_b64_tr_b16 v[252:253], v86 offset:36864
    ds_read_b64_tr_b16 v[254:255], v87 offset:36864
    s_cmp_lt_u32 s12, 3
    s_cbranch_scc0 L_B_trd
    s_barrier
L_B_trd:
    s_barrier
    s_waitcnt lgkmcnt(0)
    s_barrier
    ds_read_b128 v[96:99], v88 offset:0
    ds_read_b128 v[100:103], v88 offset:32
    ds_read_b128 v[104:107], v88 offset:64
    ds_read_b128 v[108:111], v88 offset:96
    ds_read_b128 v[112:115], v88 offset:128
    ds_read_b128 v[116:119], v88 offset:160
    ds_read_b128 v[120:123], v88 offset:192
    ds_read_b128 v[124:127], v88 offset:224
    v_mov_b32 v22, v89
    v_mov_b32 v23, v90
    s_waitcnt lgkmcnt(7)
    v_mfma_f32_32x32x16_bf16 v[32:47], v[128:131], v[96:99], 0
    s_waitcnt lgkmcnt(6)
    v_mfma_f32_32x32x16_bf16 v[32:47], v[132:135], v[100:103], v[32:47]
    s_waitcnt lgkmcnt(5)
    v_mfma_f32_32x32x16_bf16 v[32:47], v[136:139], v[104:107], v[32:47]
    s_waitcnt lgkmcnt(4)
    v_mfma_f32_32x32x16_bf16 v[32:47], v[140:143], v[108:111], v[32:47]
    s_waitcnt lgkmcnt(3)
    v_mfma_f32_32x32x16_bf16 v[32:47], v[144:147], v[112:115], v[32:47]
    s_waitcnt lgkmcnt(2)
    v_mfma_f32_32x32x16_bf16 v[32:47], v[148:151], v[116:119], v[32:47]
    s_waitcnt lgkmcnt(1)
    v_mfma_f32_32x32x16_bf16 v[32:47], v[152:155], v[120:123], v[32:47]
    s_waitcnt lgkmcnt(0)
    v_mfma_f32_32x32x16_bf16 v[32:47], v[156:159], v[124:127], v[32:47]
    v_mfma_f32_32x32x16_bf16 v[48:63], v[160:163], v[96:99], 0
    s_barrier
    v_mfma_f32_32x32x16_bf16 v[48:63], v[164:167], v[100:103], v[48:63]
    v_mfma_f32_32x32x16_bf16 v[48:63], v[168:171], v[104:107], v[48:63]
    v_mfma_f32_32x32x16_bf16 v[48:63], v[172:175], v[108:111], v[48:63]
    s_nop 6
    v_cvt_pk_bf16_f32 v14, v32, v33
    v_cvt_pk_bf16_f32 v15, v34, v35
    ds_write_b64 v22, v[14:15] offset:0
    v_mfma_f32_32x32x16_bf16 v[48:63], v[176:179], v[112:115], v[48:63]
    v_cvt_pk_bf16_f32 v16, v36, v37
    v_cvt_pk_bf16_f32 v17, v38, v39
    ds_write_b64 v22, v[16:17] offset:16
    v_mfma_f32_32x32x16_bf16 v[48:63], v[180:183], v[116:119], v[48:63]
    v_cvt_pk_bf16_f32 v18, v40, v41
    v_cvt_pk_bf16_f32 v19, v42, v43
    ds_write_b64 v22, v[18:19] offset:32
    v_mfma_f32_32x32x16_bf16 v[48:63], v[184:187], v[120:123], v[48:63]
    v_cvt_pk_bf16_f32 v20, v44, v45
    v_cvt_pk_bf16_f32 v21, v46, v47
    ds_write_b64 v22, v[20:21] offset:48
    v_mfma_f32_32x32x16_bf16 v[48:63], v[188:191], v[124:127], v[48:63]
    v_mfma_f32_32x32x16_bf16 v[64:79], v[192:195], v[96:99], 0
    v_mfma_f32_32x32x16_bf16 v[64:79], v[196:199], v[100:103], v[64:79]
    v_mfma_f32_32x32x16_bf16 v[64:79], v[200:203], v[104:107], v[64:79]
    v_mfma_f32_32x32x16_bf16 v[64:79], v[204:207], v[108:111], v[64:79]
    s_nop 7
    v_cvt_pk_bf16_f32 v14, v48, v49
    v_cvt_pk_bf16_f32 v15, v50, v51
    ds_write_b64 v22, v[14:15] offset:64
    v_mfma_f32_32x32x16_bf16 v[64:79], v[208:211], v[112:115], v[64:79]
    v_cvt_pk_bf16_f32 v16, v52, v53
    v_cvt_pk_bf16_f32 v17, v54, v55
    ds_write_b64 v22, v[16:17] offset:80
    v_mfma_f32_32x32x16_bf16 v[64:79], v[212:215], v[116:119], v[64:79]
    v_cvt_pk_bf16_f32 v18, v56, v57
    v_cvt_pk_bf16_f32 v19, v58, v59
    ds_write_b64 v22, v[18:19] offset:96
    v_mfma_f32_32x32x16_bf16 v[64:79], v[216:219], v[120:123], v[64:79]
    v_cvt_pk_bf16_f32 v20, v60, v61
    v_cvt_pk_bf16_f32 v21, v62, v63
    ds_write_b64 v22, v[20:21] offset:112
    v_mfma_f32_32x32x16_bf16 v[64:79], v[220:223], v[124:127], v[64:79]
    ds_read_b128 v[128:131], v23 offset:0
    ds_read_b128 v[132:135], v23 offset:1152
    ds_read_b128 v[136:139], v23 offset:2304
    ds_read_b128 v[140:143], v23 offset:3456
    v_mfma_f32_32x32x16_bf16 v[80:95], v[224:227], v[96:99], 0
    s_waitcnt lgkmcnt(2)
    buffer_store_dwordx4 v[128:131], v30, s[72:75], 0 offen offset:0 sc1
    buffer_store_dwordx4 v[132:135], v30, s[72:75], s53 offen offset:0 sc1
    v_mfma_f32_32x32x16_bf16 v[80:95], v[228:231], v[100:103], v[80:95]
    s_waitcnt lgkmcnt(0)
    buffer_store_dwordx4 v[136:139], v30, s[72:75], s54 offen offset:0 sc1
    buffer_store_dwordx4 v[140:143], v30, s[72:75], s55 offen offset:0 sc1
    v_mfma_f32_32x32x16_bf16 v[80:95], v[232:235], v[104:107], v[80:95]
    v_mfma_f32_32x32x16_bf16 v[80:95], v[236:239], v[108:111], v[80:95]
    v_cvt_pk_bf16_f32 v14, v64, v65
    v_cvt_pk_bf16_f32 v15, v66, v67
    ds_write_b64 v22, v[14:15] offset:8192
    v_mfma_f32_32x32x16_bf16 v[80:95], v[240:243], v[112:115], v[80:95]
    v_cvt_pk_bf16_f32 v16, v68, v69
    v_cvt_pk_bf16_f32 v17, v70, v71
    ds_write_b64 v22, v[16:17] offset:8208
    v_mfma_f32_32x32x16_bf16 v[80:95], v[244:247], v[116:119], v[80:95]
    v_cvt_pk_bf16_f32 v18, v72, v73
    v_cvt_pk_bf16_f32 v19, v74, v75
    ds_write_b64 v22, v[18:19] offset:8224
    v_mfma_f32_32x32x16_bf16 v[80:95], v[248:251], v[120:123], v[80:95]
    v_cvt_pk_bf16_f32 v20, v76, v77
    v_cvt_pk_bf16_f32 v21, v78, v79
    ds_write_b64 v22, v[20:21] offset:8240
    v_mfma_f32_32x32x16_bf16 v[80:95], v[252:255], v[124:127], v[80:95]
    s_nop 11
    v_cvt_pk_bf16_f32 v14, v80, v81
    v_cvt_pk_bf16_f32 v15, v82, v83
    ds_write_b64 v22, v[14:15] offset:8256
    v_cvt_pk_bf16_f32 v16, v84, v85
    v_cvt_pk_bf16_f32 v17, v86, v87
    ds_write_b64 v22, v[16:17] offset:8272
    v_cvt_pk_bf16_f32 v18, v88, v89
    v_cvt_pk_bf16_f32 v19, v90, v91
    ds_write_b64 v22, v[18:19] offset:8288
    v_cvt_pk_bf16_f32 v20, v92, v93
    v_cvt_pk_bf16_f32 v21, v94, v95
    ds_write_b64 v22, v[20:21] offset:8304
    ds_read_b128 v[144:147], v23 offset:8192
    ds_read_b128 v[148:151], v23 offset:9344
    ds_read_b128 v[152:155], v23 offset:10496
    ds_read_b128 v[156:159], v23 offset:11648
    s_waitcnt lgkmcnt(3)
    buffer_store_dwordx4 v[144:147], v30, s[72:75], 0 offen offset:128 sc1
    s_waitcnt lgkmcnt(2)
    buffer_store_dwordx4 v[148:151], v30, s[72:75], s53 offen offset:128 sc1
    s_waitcnt lgkmcnt(1)
    buffer_store_dwordx4 v[152:155], v30, s[72:75], s54 offen offset:128 sc1
    s_waitcnt lgkmcnt(0)
    buffer_store_dwordx4 v[156:159], v30, s[72:75], s55 offen offset:128 sc1
    s_mov_b64 exec, 1
    s_waitcnt vmcnt(0)
    s_mov_b64 exec, -1
    s_barrier
L_B_post:
    s_cmp_ge_u32 s51, 86
    s_cbranch_scc1 L_B_red
    s_mov_b32 s76, s30
    s_mov_b32 s77, s31
    s_mov_b32 s78, 1409024
    s_mov_b32 s79, 0x20000
    s_mov_b32 s80, s32
    s_mov_b32 s81, s33
    s_mov_b32 s82, 1409024
    s_mov_b32 s83, 0x20000
    v_lshrrev_b32 v4, 1, v1
    v_mul_u32_u24 v4, 2752, v4
    v_and_b32 v5, 1, v1
    v_lshl_add_u32 v4, v5, 4, v4
    s_lshl_b32 s12, s51, 1
    s_add_u32 s12, s12, s3
    s_and_b32 s12, s12, 7
    s_mul_i32 s10, s12, 176128
    s_lshl_b32 s11, s51, 5
    s_add_u32 s10, s10, s11
    s_add_u32 s11, s10, 88064
    s_lshl_b32 s12, s12, 11
    s_cmp_ge_u32 s3, 4
    s_cbranch_scc1 L_B_fulldma
    v_lshlrev_b32 v5, 4, v1
    v_add_u32 v5, s12, v5
    s_waitcnt vmcnt(0)
    ds_write_b128 v5, v[72:75] offset:0
    ds_write_b128 v5, v[76:79] offset:1024
    ds_write_b128 v5, v[80:83] offset:16384
    s_branch L_B_restdma
L_B_fulldma:
    s_add_u32 m0, s12, 0
    s_nop 0
    buffer_load_dwordx4 v4, s[76:79], s10 offen lds
    s_add_u32 m0, s12, 1024
    s_nop 0
    buffer_load_dwordx4 v4, s[76:79], s11 offen lds
    s_add_u32 m0, s12, 16384
    s_nop 0
    buffer_load_dwordx4 v4, s[80:83], s10 offen lds
L_B_restdma:
    s_add_u32 m0, s12, 17408
    s_nop 0
    buffer_load_dwordx4 v4, s[80:83], s11 offen lds
    s_mov_b32 s76, s34
    s_mov_b32 s77, s35
    s_mov_b32 s78, 1409024
    s_mov_b32 s79, 0x20000
    v_lshlrev_b32 v4, 4, v1
    s_lshl_b32 s10, s51, 14
    s_add_u32 s10, s10, s12
    s_add_u32 s11, s10, 1024
    s_add_u32 m0, s12, 32768
    s_nop 0
    buffer_load_dwordx4 v4, s[76:79], s10 offen lds
    s_add_u32 m0, s12, 33792
    s_nop 0
    buffer_load_dwordx4 v4, s[76:79], s11 offen lds
    v_mov_b32 v4, 0
    v_mov_b32 v5, 0
    v_mov_b32 v6, 73728
    ds_write_b64 v6, v[4:5]
    s_and_b32 s10, s3, 3
    s_lshl_b32 s11, s10, 12
    v_lshlrev_b32 v8, 8, v3
    v_lshl_add_u32 v8, v2, 3, v8
    v_add_u32 v8, s11, v8
    v_lshrrev_b32 v9, 2, v2
    v_lshl_add_u32 v10, v3, 2, v9
    v_lshlrev_b32 v10, 10, v10
    v_and_b32 v11, 3, v2
    v_lshl_add_u32 v10, v11, 3, v10
    s_lshl_b32 s11, s3, 7
    s_add_u32 s12, s11, 32768
    v_add_u32 v10, s12, v10
    v_lshlrev_b32 v12, 12, v9
    v_lshrrev_b32 v13, 1, v3
    v_lshl_add_u32 v12, v13, 7, v12
    v_and_b32 v13, 1, v3
    v_lshl_add_u32 v12, v13, 4, v12
    s_lshl_b32 s12, s10, 10
    s_add_u32 s12, s12, 16384
    v_add_u32 v12, s12, v12
    s_lshl_b32 s12, s10, 2
    v_lshlrev_b32 v13, 4, v1
    v_add_u32 v13, 65536, v13
    v_add_u32 v14, s12, v13
    v_lshlrev_b32 v15, 4, v3
    v_add_u32 v15, 67584, v15
    v_add_u32 v16, s12, v15
    v_cmp_eq_u32 s[56:57], v9, v3
    s_add_u32 s11, s11, 69632
    v_lshlrev_b32 v17, 1, v1
    v_add_u32 v17, s11, v17
    v_lshlrev_b32 v18, 5, v11
    v_lshl_add_u32 v18, v3, 3, v18
    v_add_u32 v18, s11, v18
    v_cmp_eq_u32 vcc, 0, v9
    s_nop 1
    v_cndmask_b32 v20, v6, v18, vcc
    v_cmp_eq_u32 vcc, 1, v9
    s_nop 1
    v_cndmask_b32 v21, v6, v18, vcc
    v_cmp_eq_u32 vcc, 2, v9
    s_nop 1
    v_cndmask_b32 v22, v6, v18, vcc
    v_cmp_eq_u32 vcc, 3, v9
    s_nop 1
    v_cndmask_b32 v23, v6, v18, vcc
    s_waitcnt vmcnt(0) lgkmcnt(0)
    s_barrier
    ds_read_b64_tr_b16 v[64:65], v10 offset:0
    ds_read_b64_tr_b16 v[66:67], v10 offset:32
    ds_read_b64_tr_b16 v[68:69], v10 offset:64
    ds_read_b64_tr_b16 v[70:71], v10 offset:96
    ds_read_b64_tr_b16 v[32:33], v8 offset:0
    ds_read_b64_tr_b16 v[34:35], v8 offset:128
    ds_read_b64_tr_b16 v[36:37], v8 offset:1024
    ds_read_b64_tr_b16 v[38:39], v8 offset:1152
    ds_read_b64_tr_b16 v[40:41], v8 offset:2048
    ds_read_b64_tr_b16 v[42:43], v8 offset:2176
    ds_read_b64_tr_b16 v[44:45], v8 offset:3072
    ds_read_b64_tr_b16 v[46:47], v8 offset:3200
    ds_read_b64_tr_b16 v[48:49], v8 offset:16384
    ds_read_b64_tr_b16 v[50:51], v8 offset:16512
    ds_read_b64_tr_b16 v[52:53], v8 offset:17408
    ds_read_b64_tr_b16 v[54:55], v8 offset:17536
    ds_read_b64_tr_b16 v[56:57], v8 offset:18432
    ds_read_b64_tr_b16 v[58:59], v8 offset:18560
    ds_read_b64_tr_b16 v[60:61], v8 offset:19456
    ds_read_b64_tr_b16 v[62:63], v8 offset:19584
    v_mov_b32 v72, 0x3f803f80
    v_mov_b32 v73, 0x3f803f80
    v_mov_b32 v74, 0x3f803f80
    v_mov_b32 v75, 0x3f803f80
    s_waitcnt lgkmcnt(0)
    s_nop 0
    v_mfma_f32_16x16x32_bf16 v[76:79], v[72:75], v[32:35], 0
    v_mfma_f32_16x16x32_bf16 v[80:83], v[72:75], v[48:51], 0
    v_mfma_f32_16x16x32_bf16 v[76:79], v[72:75], v[36:39], v[76:79]
    v_mfma_f32_16x16x32_bf16 v[80:83], v[72:75], v[52:55], v[80:83]
    v_mfma_f32_16x16x32_bf16 v[76:79], v[72:75], v[40:43], v[76:79]
    v_mfma_f32_16x16x32_bf16 v[80:83], v[72:75], v[56:59], v[80:83]
    v_mfma_f32_16x16x32_bf16 v[76:79], v[72:75], v[44:47], v[76:79]
    v_mfma_f32_16x16x32_bf16 v[80:83], v[72:75], v[60:63], v[80:83]
    s_nop 6
    ds_write_b32 v14, v76
    ds_write_b32 v14, v80 offset:1024
    s_waitcnt lgkmcnt(0)
    s_barrier
    ds_read_b128 v[76:79], v13
    ds_read_b128 v[80:83], v13 offset:1024
    s_waitcnt lgkmcnt(0)
    v_add_f32 v76, v76, v77
    v_add_f32 v78, v78, v79
    v_add_f32 v24, v76, v78
    v_add_f32 v80, v80, v81
    v_add_f32 v82, v82, v83
    v_add_f32 v25, v80, v82
    s_barrier
    s_branch L_B_hcan
L_B_red:
    s_cmp_lt_u32 s5, 12
    s_cbranch_scc1 L_end
    s_cmp_ge_u32 s3, 4
    s_cbranch_scc1 L_end
    s_lshl_b32 s9, s4, 2
    s_add_u32 s9, s9, s5
    s_sub_u32 s9, s9, 12
    s_lshl_b32 s9, s9, 2
    s_add_u32 s9, s9, s3
    s_lshr_b32 s6, s9, 5
    s_and_b32 s7, s9, 31
    v_and_b32 v4, 1, v2
    v_lshlrev_b32 v4, 4, v4
    v_mov_b32 v5, 0xffff
    v_lshlrev_b32 v4, v4, v5
    v_lshrrev_b32 v5, 1, v2
    v_cmp_eq_u32 vcc, 0, v5
    s_nop 1
    v_cndmask_b32 v112, 0, v4, vcc
    v_cmp_eq_u32 vcc, 1, v5
    s_nop 1
    v_cndmask_b32 v113, 0, v4, vcc
    v_cmp_eq_u32 vcc, 2, v5
    s_nop 1
    v_cndmask_b32 v114, 0, v4, vcc
    v_cmp_eq_u32 vcc, 3, v5
    s_nop 1
    v_cndmask_b32 v115, 0, v4, vcc
    v_and_b32 v112, 0x3f803f80, v112
    v_and_b32 v113, 0x3f803f80, v113
    v_and_b32 v114, 0x3f803f80, v114
    v_and_b32 v115, 0x3f803f80, v115
    v_lshrrev_b32 v4, 1, v2
    v_lshl_add_u32 v4, v3, 3, v4
    v_and_b32 v5, 1, v2
    v_lshlrev_b32 v5, 4, v5
    v_lshl_add_u32 v26, v3, 3, v5
    s_lshl_b32 s10, s9, 5
    v_and_b32 v27, 31, v26
    v_add_u32 v27, s10, v27
    global_load_dwordx2 v[28:29], v27, s[16:17]
    s_lshl_b32 s10, s6, 17
    s_lshl_b32 s11, s7, 5
    s_add_u32 s10, s10, s11
    s_add_u32 s10, s10, 1048576
    v_lshl_add_u32 v4, v4, 10, v5
    v_add_u32 v4, s10, v4
    s_lshl_b32 s10, s9, 7
    s_add_u32 s10, s10, 16384
    v_add_u32 v26, s10, v26
    s_mov_b32 s10, 65536
    s_mov_b32 s11, 98304
    v_cmp_gt_u32 vcc, 2, v2
    s_waitcnt vmcnt(0)
    s_nop 0
    v_cndmask_b32 v28, 0, v28, vcc
    v_cndmask_b32 v29, 0, v29, vcc
    v_lshlrev_b32 v120, 16, v28
    v_and_b32 v121, 0xffff0000, v28
    v_lshlrev_b32 v122, 16, v29
    v_and_b32 v123, 0xffff0000, v29
    s_mov_b64 exec, 0x1
Lcan_19:
    buffer_load_dwordx4 v[96:99], v4, s[72:75], 0 offen sc1
    s_waitcnt vmcnt(0)
    v_cmp_eq_u32 vcc, -1, v96
    s_cbranch_vccz Lcand_20
    s_sleep 1
    s_sub_u32 s13, s13, 1
    s_cbranch_scc0 Lcan_19
    s_mov_b32 s13, 0
Lcand_20:
    s_mov_b64 exec, -1
Lsp_21:
    buffer_load_dwordx4 v[96:99], v4, s[72:75], 0 offen sc1
    buffer_load_dwordx4 v[100:103], v4, s[72:75], s68 offen sc1
    buffer_load_dwordx4 v[104:107], v4, s[72:75], s10 offen sc1
    buffer_load_dwordx4 v[108:111], v4, s[72:75], s11 offen sc1
    s_waitcnt vmcnt(0)
    v_max3_u32 v5, v96, v97, v98
    v_max3_u32 v5, v5, v99, v100
    v_max3_u32 v5, v5, v101, v102
    v_max3_u32 v5, v5, v103, v104
    v_max3_u32 v5, v5, v105, v106
    v_max3_u32 v5, v5, v107, v108
    v_max3_u32 v5, v5, v109, v110
    v_max_u32 v5, v5, v111
    v_cmp_eq_u32 vcc, -1, v5
    s_cbranch_vccz Lok_22
    s_sub_u32 s13, s13, 1
    s_cbranch_scc0 Lsp_21
    s_mov_b32 s13, 0
Lok_22:
    v_mfma_f32_16x16x32_bf16 v[116:119], v[112:115], v[96:99], v[120:123]
    v_mfma_f32_16x16x32_bf16 v[116:119], v[112:115], v[100:103], v[116:119]
    v_mfma_f32_16x16x32_bf16 v[116:119], v[112:115], v[104:107], v[116:119]
    v_mfma_f32_16x16x32_bf16 v[116:119], v[112:115], v[108:111], v[116:119]
    s_nop 7
    v_add_f32_dpp v116, v116, v116 row_ror:2 row_mask:0xf bank_mask:0xf
    v_add_f32_dpp v117, v117, v117 row_ror:2 row_mask:0xf bank_mask:0xf
    v_add_f32_dpp v118, v118, v118 row_ror:2 row_mask:0xf bank_mask:0xf
    v_add_f32_dpp v119, v119, v119 row_ror:2 row_mask:0xf bank_mask:0xf
    v_add_f32_dpp v116, v116, v116 row_ror:4 row_mask:0xf bank_mask:0xf
    v_add_f32_dpp v117, v117, v117 row_ror:4 row_mask:0xf bank_mask:0xf
    v_add_f32_dpp v118, v118, v118 row_ror:4 row_mask:0xf bank_mask:0xf
    v_add_f32_dpp v119, v119, v119 row_ror:4 row_mask:0xf bank_mask:0xf
    v_add_f32_dpp v116, v116, v116 row_ror:8 row_mask:0xf bank_mask:0xf
    v_add_f32_dpp v117, v117, v117 row_ror:8 row_mask:0xf bank_mask:0xf
    v_add_f32_dpp v118, v118, v118 row_ror:8 row_mask:0xf bank_mask:0xf
    v_add_f32_dpp v119, v119, v119 row_ror:8 row_mask:0xf bank_mask:0xf
    v_cvt_pk_bf16_f32 v28, v116, v117
    v_cvt_pk_bf16_f32 v29, v118, v119
    s_mov_b64 exec, 0x00030003
    buffer_store_dwordx2 v[28:29], v26, s[72:75], 0 offen sc1
    s_endpgm
L_B_hcan:
    s_mov_b64 exec, 0x1
Lcan_23:
    buffer_load_dwordx4 v[96:99], v12, s[72:75], 0 offen sc1
    s_waitcnt vmcnt(0)
    v_cmp_eq_u32 vcc, -1, v96
    s_cbranch_vccz Lcand_24
    s_sleep 1
    s_sub_u32 s13, s13, 1
    s_cbranch_scc0 Lcan_23
    s_mov_b32 s13, 0
Lcand_24:
    s_mov_b64 exec, -1
Lsp_25:
    buffer_load_dwordx4 v[96:99], v12, s[72:75], 0 offen offset:0 sc1
    buffer_load_dwordx4 v[100:103], v12, s[72:75], 0 offen offset:256 sc1
    buffer_load_dwordx4 v[104:107], v12, s[72:75], 0 offen offset:512 sc1
    buffer_load_dwordx4 v[108:111], v12, s[72:75], 0 offen offset:768 sc1
    s_waitcnt vmcnt(0)
    v_max3_u32 v5, v96, v97, v98
    v_max3_u32 v5, v5, v99, v100
    v_max3_u32 v5, v5, v101, v102
    v_max3_u32 v5, v5, v103, v104
    v_max3_u32 v5, v5, v105, v106
    v_max3_u32 v5, v5, v107, v108
    v_max3_u32 v5, v5, v109, v110
    v_max_u32 v5, v5, v111
    v_cmp_eq_u32 vcc, -1, v5
    s_cbranch_vccz Lok_26
    s_sub_u32 s13, s13, 1
    s_cbranch_scc0 Lsp_25
    s_mov_b32 s13, 0
Lok_26:
    s_cmp_ge_u32 s3, 4
    s_cbranch_scc1 L_B_stats
    v_mfma_f32_16x16x32_bf16 v[76:79], v[96:99], v[32:35], 0
    v_mfma_f32_16x16x32_bf16 v[80:83], v[96:99], v[48:51], 0
    v_mfma_f32_16x16x32_bf16 v[76:79], v[100:103], v[36:39], v[76:79]
    v_mfma_f32_16x16x32_bf16 v[80:83], v[100:103], v[52:55], v[80:83]
    v_mfma_f32_16x16x32_bf16 v[76:79], v[104:107], v[40:43], v[76:79]
    v_mfma_f32_16x16x32_bf16 v[80:83], v[104:107], v[56:59], v[80:83]
    v_mfma_f32_16x16x32_bf16 v[76:79], v[108:111], v[44:47], v[76:79]
    v_mfma_f32_16x16x32_bf16 v[80:83], v[108:111], v[60:63], v[80:83]
    s_nop 6
    ds_write_b32 v14, v76
    ds_write_b32 v14, v80 offset:1024
    s_branch L_B_f1done
L_B_stats:
    v_mfma_f32_16x16x32_bf16 v[76:79], v[96:99], v[72:75], 0
    v_mfma_f32_16x16x32_bf16 v[80:83], v[96:99], v[96:99], 0
    v_mfma_f32_16x16x32_bf16 v[76:79], v[100:103], v[72:75], v[76:79]
    v_mfma_f32_16x16x32_bf16 v[80:83], v[100:103], v[100:103], v[80:83]
    v_mfma_f32_16x16x32_bf16 v[76:79], v[104:107], v[72:75], v[76:79]
    v_mfma_f32_16x16x32_bf16 v[80:83], v[104:107], v[104:107], v[80:83]
    v_mfma_f32_16x16x32_bf16 v[76:79], v[108:111], v[72:75], v[76:79]
    v_mfma_f32_16x16x32_bf16 v[80:83], v[108:111], v[108:111], v[80:83]
    s_mov_b64 exec, s[56:57]
    s_nop 5
    ds_write_b32 v16, v76
    ds_write_b32 v16, v80 offset:64
    s_mov_b64 exec, -1
L_B_f1done:
    s_waitcnt lgkmcnt(0)
    s_barrier
    ds_read_b128 v[84:87], v15
    ds_read_b128 v[88:91], v15 offset:64
    ds_read_b128 v[76:79], v13
    ds_read_b128 v[80:83], v13 offset:1024
    s_waitcnt lgkmcnt(2)
    v_add_f32 v84, v84, v85
    v_add_f32 v86, v86, v87
    v_add_f32 v84, v84, v86
    v_add_f32 v88, v88, v89
    v_add_f32 v90, v90, v91
    v_add_f32 v88, v88, v90
    v_mul_f32 v84, 0x3b000000, v84
    v_mul_f32 v88, 0x3b000000, v88
    v_fma_f32 v88, -v84, v84, v88
    v_max_f32 v88, 0, v88
    v_add_f32 v88, 0x3727c5ac, v88
    v_rsq_f32 v88, v88
    s_waitcnt lgkmcnt(0)
    v_add_f32 v76, v76, v77
    v_add_f32 v78, v78, v79
    v_add_f32 v76, v76, v78
    v_add_f32 v80, v80, v81
    v_add_f32 v82, v82, v83
    v_add_f32 v80, v80, v82
    v_fma_f32 v76, -v84, v24, v76
    v_fma_f32 v80, -v84, v25, v80
    v_mul_f32 v76, v76, v88
    v_mul_f32 v80, v80, v88
    v_mul_f32 v77, 0xbfb8aa3b, v76
    v_exp_f32 v77, v77
    v_mul_f32 v76, v76, v80
    v_add_f32 v77, 1.0, v77
    v_rcp_f32 v77, v77
    s_nop 0
    v_mul_f32 v76, v76, v77
    v_cvt_pk_bf16_f32 v76, v76, v76
    ds_write_b16 v17, v76
    s_waitcnt lgkmcnt(0)
    ds_read_b64 v[84:85], v20
    ds_read_b64 v[86:87], v21
    ds_read_b64 v[88:89], v22
    ds_read_b64 v[90:91], v23
    s_waitcnt lgkmcnt(3)
    v_mfma_f32_16x16x16_bf16 v[76:79], v[64:65], v[84:85], 0
    s_waitcnt lgkmcnt(2)
    v_mfma_f32_16x16x16_bf16 v[76:79], v[66:67], v[86:87], v[76:79]
    s_waitcnt lgkmcnt(1)
    v_mfma_f32_16x16x16_bf16 v[76:79], v[68:69], v[88:89], v[76:79]
    s_waitcnt lgkmcnt(0)
    v_mfma_f32_16x16x16_bf16 v[76:79], v[70:71], v[90:91], v[76:79]
    s_nop 7
    v_cvt_pk_bf16_f32 v80, v76, v77
    v_cvt_pk_bf16_f32 v81, v78, v79
    buffer_store_dwordx2 v[80:81], v31, s[72:75], 0 offen sc1
L_end:
    s_endpgm
L_code_end:
.section .rodata,"a"
.p2align 6
.amdhsa_kernel sequential_preLN__compressed_kv_cla__swiglu_ffn__decode_kernel
  .amdhsa_next_free_vgpr 256
  .amdhsa_next_free_sgpr 102
  .amdhsa_accum_offset 256
  .amdhsa_group_segment_fixed_size 0
  .amdhsa_kernarg_size 104
  .amdhsa_user_sgpr_count 2
  .amdhsa_user_sgpr_kernarg_segment_ptr 1
  .amdhsa_system_sgpr_workgroup_id_x 1
.end_amdhsa_kernel
```
